```python
import torch

def _softmax(x, axis=-1):
    return torch.softmax(x, dim=axis)
def _gelu(x):
    return torch.nn.functional.gelu(x, approximate="tanh")
def _silu(x):
    return torch.nn.functional.silu(x)
def _sigmoid(x):
    return torch.sigmoid(x)
def _layernorm(x, axis=-1, eps=1e-5):
    m = x.mean(dim=axis, keepdim=True)
    v = x.var(dim=axis, keepdim=True, unbiased=False)
    return (x - m) / torch.sqrt(v + eps)
def _scatter_add(tgt, idx, src, axis=0):
    return tgt.clone().index_add_(axis, idx, src)
def _segment_sum(src, seg, n):
    out = torch.zeros((n,) + src.shape[1:], dtype=src.dtype)
    return out.index_add_(0, seg, src)
def _pad(x, pw):
    flat = tuple(v for pair in reversed(pw) for v in pair)
    return torch.nn.functional.pad(x, flat)

kernel_name = 'gated_mix__linear_kernel_hedgehog__dense_activation_silu__prompt'

def setup_inputs():

    _w = (lambda a: (lambda t: t.to(torch.bfloat16) if t.is_floating_point() else t)(torch.as_tensor(a)))
    def _A_setup():
        B, S, D, H = 1, 2048, 448, 16
        Dh = D // H
        return {
            "x": _w((lambda *s: torch.randn(*s, dtype=torch.bfloat16) * 0.05)(B, S, D)),
            "wqkv": _w((lambda *s: torch.randn(*s, dtype=torch.bfloat16) * 0.8)(D, 3 * D)),
            "w_phi": _w((lambda *s: torch.randn(*s, dtype=torch.bfloat16) * 0.8)(H, Dh, Dh) * (Dh ** -0.5)),
            "wo": _w((lambda *s: torch.randn(*s, dtype=torch.bfloat16) * 0.05)(D, D)),
        }
    _A_in = _A_setup()

    def _B_setup():
        B, S, D, F = 1, 2048, 448, 1792
        return {
            "x": _w((lambda *s: torch.randn(*s, dtype=torch.bfloat16) * 0.05)(B, S, D)),
            "w1": _w((lambda *s: torch.randn(*s, dtype=torch.bfloat16) * 3.2)(D, F) * (D ** -0.5)),
            "w2": _w((lambda *s: torch.randn(*s, dtype=torch.bfloat16) * 0.2)(F, D) * (F ** -0.5)),
        }
    _B_in = _B_setup()

    return {
        "A_x": _A_in["x"],
        "A_wqkv": _A_in["wqkv"],
        "A_w_phi": _A_in["w_phi"],
        "A_wo": _A_in["wo"],
        "B_x": _B_in["x"],
        "B_w1": _B_in["w1"],
        "B_w2": _B_in["w2"],
        "gate_w": _w((lambda *s: torch.randn(*s, dtype=torch.bfloat16) * 0.05)(448) * 16.0),
    }

def reference(A_x, A_wqkv, A_w_phi, A_wo, B_x, B_w1, B_w2, gate_w):
    def _A_ref(x, wqkv, w_phi, wo):
        B, S, D = x.shape
        H = 16; Dh = D // H
        qkv = (lambda x, *d: x.permute(*d))((x @ wqkv).reshape(B, S, 3, H, Dh), 2, 0, 3, 1, 4)
        q, k, v = qkv[0], qkv[1], qkv[2]
        pq = torch.einsum("bhsd,hdf->bhsf", q, w_phi)
        pk = torch.einsum("bhsd,hdf->bhsf", k, w_phi)
        phi_q = torch.concatenate([_softmax(pq, axis=-1), _softmax(-pq, axis=-1)], axis=-1)
        phi_k = torch.concatenate([_softmax(pk, axis=-1), _softmax(-pk, axis=-1)], axis=-1)
        kv = torch.einsum("bhsf,bhsd->bhfd", phi_k, v)
        z  = torch.einsum("bhsf->bhf", phi_k)
        num = torch.einsum("bhqf,bhfd->bhqd", phi_q, kv)
        den = torch.einsum("bhqf,bhf->bhq", phi_q, z)[..., None] + 1e-6
        o = num / den
        return (lambda x, *d: x.permute(*d))(o, 0, 2, 1, 3).reshape(B, S, D) @ wo

    def _B_ref(x, w1, w2):
        h = torch.einsum("bsd,df->bsf", x, w1)
        h = _silu(h)
        out = torch.einsum("bsf,fd->bsd", h, w2)
        return out

    x = A_x
    g = _sigmoid((x * gate_w).sum(-1, keepdims=True))
    a = _A_ref(x, A_wqkv, A_w_phi, A_wo)
    b = _B_ref(x, B_w1, B_w2)
    return g * a + (1 - g) * b
```

```asm
; @launch grid=(256,1,1) block=(512,1,1) lds=163840
.amdgcn_target "amdgcn-amd-amdhsa--gfx950"
.text
.globl gated_mix__linear_kernel_hedgehog__dense_activation_silu__prompt_kernel
.p2align 8
.type gated_mix__linear_kernel_hedgehog__dense_activation_silu__prompt_kernel,@function
gated_mix__linear_kernel_hedgehog__dense_activation_silu__prompt_kernel:
  s_cmp_ge_u32 s2, 256
  s_cbranch_scc1 L_end
  s_load_dwordx16 s[64:79], s[0:1], 0
  s_load_dwordx4 s[4:7], s[0:1], 64
  s_load_dwordx2 s[24:25], s[0:1], 80
  s_memrealtime s[90:91]
  s_getpc_b64 s[92:93]
  s_and_b32 s92, s92, 0xffffff00
  v_and_b32 v1, 63, v0
  v_lshrrev_b32 v2, 6, v0
  s_lshr_b32 s49, s2, 3
  v_readfirstlane_b32 s3, v2
  v_mov_b32 v0, v1
  s_lshl_b32 s50, s49, 11
  v_lshlrev_b32 v3, 7, v0
  v_add_u32 v3, s50, v3
  s_cmp_lg_u32 s3, 7
  s_cbranch_scc1 L_nopf
  v_cmp_gt_u32 vcc, 0x7bbc, v3
  s_nop 0
  s_and_b64 exec, vcc, 0xffff
  s_nop 1
  s_cbranch_execz L_nopf2
  global_load_dword v7, v3, s[92:93]
L_nopf2:
  s_mov_b64 exec, -1
L_nopf:
  s_and_b32 s50, s2, 7
  s_lshr_b32 s51, s50, 1
  s_and_b32 s52, s50, 1
  s_and_b32 s53, s49, 15
  s_lshr_b32 s54, s53, 2
  s_and_b32 s55, s53, 3
  s_lshl_b32 s44, s51, 2
  s_add_u32 s44, s44, s54
  s_lshl_b32 s45, s52, 2
  s_add_u32 s45, s45, s55
  s_xor_b32 s89, s49, 16
  s_mul_i32 s51, s89, 37
  s_lshr_b32 s51, s51, 8
  s_mul_i32 s52, s51, 7
  s_sub_u32 s47, s89, s52
  s_lshl_b32 s46, s50, 2
  s_add_u32 s46, s46, s51
  s_mov_b32 s62, 0x3fb8aa3b
  s_mov_b32 s63, 0xbfb8aa3b
  s_mov_b32 s60, 0
  s_mov_b32 s61, -1
  s_mov_b32 s80, 0x10000000
  s_mov_b32 s81, 0x10000000
  s_mov_b32 s82, 0xf0000000
  s_mov_b32 s83, 0xf0000000
  s_mov_b32 s10, 1835008
  s_mov_b32 s11, 0x00020000
  s_mov_b32 s15, 0x00020000
  s_mov_b32 s18, 1605632
  s_mov_b32 s19, 0x00020000
  s_mov_b32 s22, 401408
  s_mov_b32 s23, 0x00020000
  s_mov_b32 s26, 0x10000000
  s_mov_b32 s27, 0x00020000
  s_mov_b32 s30, 1835008
  s_mov_b32 s31, 0x00020000
  s_mov_b32 s34, 256
  s_mov_b32 s35, 0x00020000
  s_mov_b32 s38, 25088
  s_mov_b32 s39, 0x00020000
  s_mov_b32 s42, 896
  s_mov_b32 s43, 0x00020000
  v_lshrrev_b32 v1, 3, v0
  v_and_b32 v2, 7, v0
  v_lshrrev_b32 v3, 1, v1
  v_xor_b32 v2, v2, v3
  v_mul_u32_u24 v1, 896, v1
  v_lshl_add_u32 v10, v2, 4, v1
  v_xor_b32 v2, 4, v2
  v_lshl_add_u32 v11, v2, 4, v1
  v_add_u32 v11, 7168, v11
  s_lshl_b32 s50, s44, 7
  s_lshl_b32 s51, s3, 4
  s_add_u32 s50, s50, s51
  s_mul_i32 s56, s50, 896
  s_lshl_b32 s57, s3, 11
  s_lshl_b32 s59, s3, 10
  s_waitcnt lgkmcnt(0)
  s_mov_b32 s8, s64
  s_mov_b32 s9, s65
  s_mov_b32 s16, s76
  s_mov_b32 s17, s77
  s_mov_b32 s20, s70
  s_mov_b32 s21, s71
  s_mov_b32 s28, s4
  s_mov_b32 s29, s5
  s_mov_b32 s32, s6
  s_mov_b32 s33, s7
  s_mov_b32 s36, s68
  s_mov_b32 s37, s69
  s_mov_b32 s40, s78
  s_mov_b32 s41, s79
  s_or_b32 s48, s90, 1
  s_or_b32 s50, s2, s3
  s_cmp_lg_u32 s50, 0
  s_cbranch_scc1 L_nononce
  v_mov_b32 v4, s48
  v_mov_b32 v5, 0
  s_mov_b64 exec, 1
  buffer_store_dword v4, v5, s[32:35], 0 offen sc1
  s_mov_b64 exec, -1
L_nononce:
  s_cmp_lt_u32 s49, 16
  s_cbranch_scc1 L_att
  s_mov_b32 s12, s74
  s_mov_b32 s13, s75
  s_mov_b32 s14, 1605632
  v_lshrrev_b32 v1, 3, v0
  v_and_b32 v2, 7, v0
  v_lshrrev_b32 v3, 1, v1
  v_and_b32 v3, 1, v3
  v_lshlrev_b32 v3, 2, v3
  v_xor_b32 v2, v2, v3
  v_min_u32 v2, 7, v2
  v_mul_u32_u24 v1, 3584, v1
  v_lshl_add_u32 v12, v2, 4, v1
  s_and_b32 s74, s45, 1
  s_mul_i32 s50, s45, 448
  s_mul_i32 s51, s3, 28672
  s_add_u32 s50, s50, s51
  s_lshl_b32 s52, s74, 6
  s_add_u32 s58, s50, s52
  s_mul_i32 s52, s74, 448
  s_add_u32 s73, s50, 384
  s_sub_u32 s73, s73, s52
  s_add_u32 s50, s44, s45
  s_and_b32 s50, s50, 3
  s_lshl_b32 s50, s50, 1
  s_add_u32 s51, s50, 0
  s_cmp_ge_u32 s51, 7
  s_cselect_b32 s52, 7, 0
  s_sub_u32 s51, s51, s52
  s_lshl_b32 s65, s51, 7
  s_mul_i32 s90, s65, 1792
  s_add_u32 s51, s50, 1
  s_cmp_ge_u32 s51, 7
  s_cselect_b32 s52, 7, 0
  s_sub_u32 s51, s51, s52
  s_lshl_b32 s66, s51, 7
  s_mul_i32 s91, s66, 1792
  s_add_u32 s51, s50, 2
  s_cmp_ge_u32 s51, 7
  s_cselect_b32 s52, 7, 0
  s_sub_u32 s51, s51, s52
  s_lshl_b32 s67, s51, 7
  s_mul_i32 s92, s67, 1792
  s_add_u32 s51, s50, 3
  s_cmp_ge_u32 s51, 7
  s_cselect_b32 s52, 7, 0
  s_sub_u32 s51, s51, s52
  s_lshl_b32 s68, s51, 7
  s_mul_i32 s93, s68, 1792
  s_add_u32 s51, s50, 4
  s_cmp_ge_u32 s51, 7
  s_cselect_b32 s52, 7, 0
  s_sub_u32 s51, s51, s52
  s_lshl_b32 s69, s51, 7
  s_mul_i32 s94, s69, 1792
  s_add_u32 s51, s50, 5
  s_cmp_ge_u32 s51, 7
  s_cselect_b32 s52, 7, 0
  s_sub_u32 s51, s51, s52
  s_lshl_b32 s70, s51, 7
  s_mul_i32 s95, s70, 1792
  s_add_u32 s51, s50, 6
  s_cmp_ge_u32 s51, 7
  s_cselect_b32 s52, 7, 0
  s_sub_u32 s51, s51, s52
  s_lshl_b32 s71, s51, 7
  s_mul_i32 s96, s71, 1792
  v_add_u32 v10, s56, v10
  v_add_u32 v11, s56, v11
  v_add_u32 v9, s73, v12
  v_add_u32 v12, s58, v12
  s_add_u32 m0, s57, 0
  s_nop 0
  buffer_load_dwordx4 v10, s[8:11], s65 offen lds
  s_add_u32 m0, s57, 1024
  s_nop 0
  buffer_load_dwordx4 v11, s[8:11], s65 offen lds
  s_add_u32 m0, s59, 147456
  s_nop 0
  buffer_load_dwordx4 v12, s[12:15], s90 offen lds
  s_add_u32 m0, s59, 139136
  s_nop 0
  buffer_load_dwordx4 v12, s[12:15], s90 offen offset:128 lds
  v_lshlrev_b32 v1, 4, v0
  s_mov_b32 m0, 155648
  s_nop 0
  buffer_load_dwordx4 v1, s[40:43], 0 offen lds
  s_barrier
  s_add_u32 m0, s57, 16384
  s_nop 0
  buffer_load_dwordx4 v10, s[8:11], s66 offen lds
  s_add_u32 m0, s57, 17408
  s_nop 0
  buffer_load_dwordx4 v11, s[8:11], s66 offen lds
  s_add_u32 m0, s59, 131072
  s_nop 0
  buffer_load_dwordx4 v12, s[12:15], s91 offen lds
  s_add_u32 m0, s59, 122752
  s_nop 0
  buffer_load_dwordx4 v12, s[12:15], s91 offen offset:128 lds
  v_and_b32 v1, 31, v0
  v_lshrrev_b32 v2, 5, v0
  v_lshrrev_b32 v3, 1, v1
  v_and_b32 v3, 7, v3
  v_xor_b32 v2, v2, v3
  v_lshlrev_b32 v1, 7, v1
  s_and_b32 s50, s3, 3
  s_lshl_b32 s50, s50, 12
  v_add_u32 v1, s50, v1
  v_xor_b32 v3, 0, v2
  v_lshl_add_u32 v248, v3, 4, v1
  v_add_u32 v40, 0x10000, v248
  v_add_u32 v188, 0x20000, v248
  v_xor_b32 v3, 2, v2
  v_lshl_add_u32 v249, v3, 4, v1
  v_add_u32 v41, 0x10000, v249
  v_add_u32 v189, 0x20000, v249
  v_xor_b32 v3, 4, v2
  v_lshl_add_u32 v250, v3, 4, v1
  v_add_u32 v42, 0x10000, v250
  v_add_u32 v190, 0x20000, v250
  v_xor_b32 v3, 6, v2
  v_lshl_add_u32 v251, v3, 4, v1
  v_add_u32 v43, 0x10000, v251
  v_add_u32 v191, 0x20000, v251
  s_lshr_b32 s54, s3, 2
  s_mul_i32 s51, s54, 64
  v_bfe_u32 v1, v0, 4, 1
  v_lshlrev_b32 v1, 5, v1
  v_and_b32 v2, 3, v0
  v_lshl_add_u32 v1, v2, 3, v1
  v_add_u32 v1, s51, v1
  v_bfe_u32 v2, v0, 2, 2
  v_lshrrev_b32 v3, 1, v2
  v_lshlrev_b32 v3, 6, v3
  v_xor_b32 v1, v1, v3
  v_lshrrev_b32 v3, 5, v0
  v_lshl_add_u32 v3, v3, 3, v2
  v_lshl_add_u32 v13, v3, 7, v1
  v_add_u32 v14, 0x10000, v13
  v_add_u32 v15, 0x20000, v13
  v_lshrrev_b32 v1, 5, v0
  v_lshlrev_b32 v1, 4, v1
  v_add_u32 v252, 155648, v1
  s_lshl_b32 s50, s44, 2
  s_and_b32 s51, s3, 3
  s_add_u32 s50, s50, s51
  s_mul_i32 s50, s50, 144
  s_mul_i32 s51, s45, 14
  s_add_u32 s50, s50, s51
  s_lshr_b32 s51, s3, 2
  s_add_u32 s51, s51, s74
  s_lshl_b32 s51, s51, 1
  s_add_u32 s51, s51, s50
  s_lshl_b32 s64, s51, 10
  s_mul_i32 s51, s74, 12
  s_add_u32 s50, s50, 12
  s_sub_u32 s50, s50, s51
  s_lshl_b32 s72, s50, 10
  s_waitcnt vmcnt(4)
  s_barrier
  ds_read_b128 v[44:47], v248 offset:0
  ds_read_b64_tr_b16 v[16:17], v15 offset:16384
  ds_read_b64_tr_b16 v[18:19], v15 offset:16896
  ds_read_b64_tr_b16 v[20:21], v15 offset:8192
  ds_read_b64_tr_b16 v[22:23], v15 offset:8704
  ds_read_b128 v[48:51], v249 offset:0
  ds_read_b64_tr_b16 v[24:25], v15 offset:18432
  ds_read_b64_tr_b16 v[26:27], v15 offset:18944
  ds_read_b64_tr_b16 v[28:29], v15 offset:10240
  ds_read_b64_tr_b16 v[30:31], v15 offset:10752
  s_waitcnt lgkmcnt(5)
  v_mfma_f32_32x32x16_bf16 v[156:171], v[16:19], v[44:47], 0
  v_mfma_f32_32x32x16_bf16 v[172:187], v[20:23], v[44:47], 0
  ds_read_b128 v[52:55], v250 offset:0
  ds_read_b64_tr_b16 v[32:33], v15 offset:20480
  ds_read_b64_tr_b16 v[34:35], v15 offset:20992
  ds_read_b64_tr_b16 v[36:37], v15 offset:12288
  ds_read_b64_tr_b16 v[38:39], v15 offset:12800
  s_add_u32 m0, s57, 32768
  s_nop 0
  buffer_load_dwordx4 v10, s[8:11], s67 offen lds
  s_waitcnt lgkmcnt(5)
  v_mfma_f32_32x32x16_bf16 v[156:171], v[24:27], v[48:51], v[156:171]
  v_mfma_f32_32x32x16_bf16 v[172:187], v[28:31], v[48:51], v[172:187]
  ds_read_b128 v[56:59], v251 offset:0
  ds_read_b64_tr_b16 v[16:17], v15 offset:22528
  ds_read_b64_tr_b16 v[18:19], v15 offset:23040
  ds_read_b64_tr_b16 v[20:21], v15 offset:14336
  ds_read_b64_tr_b16 v[22:23], v15 offset:14848
  s_add_u32 m0, s57, 33792
  s_nop 0
  buffer_load_dwordx4 v11, s[8:11], s67 offen lds
  s_waitcnt vmcnt(2)
  s_barrier
  s_waitcnt lgkmcnt(5)
  v_mfma_f32_32x32x16_bf16 v[156:171], v[32:35], v[52:55], v[156:171]
  v_mfma_f32_32x32x16_bf16 v[172:187], v[36:39], v[52:55], v[172:187]
  ds_read_b128 v[60:63], v248 offset:16384
  ds_read_b64_tr_b16 v[24:25], v15 offset:0
  ds_read_b64_tr_b16 v[26:27], v15 offset:512
  ds_read_b64_tr_b16 v[28:29], v14 offset:57344
  ds_read_b64_tr_b16 v[30:31], v14 offset:57856
  s_add_u32 m0, s59, 114688
  s_nop 0
  buffer_load_dwordx4 v12, s[12:15], s92 offen lds
  s_waitcnt lgkmcnt(5)
  v_mfma_f32_32x32x16_bf16 v[156:171], v[16:19], v[56:59], v[156:171]
  v_mfma_f32_32x32x16_bf16 v[172:187], v[20:23], v[56:59], v[172:187]
  ds_read_b128 v[64:67], v249 offset:16384
  ds_read_b64_tr_b16 v[32:33], v15 offset:2048
  ds_read_b64_tr_b16 v[34:35], v15 offset:2560
  ds_read_b64_tr_b16 v[36:37], v14 offset:59392
  ds_read_b64_tr_b16 v[38:39], v14 offset:59904
  s_add_u32 m0, s59, 106368
  s_nop 0
  buffer_load_dwordx4 v12, s[12:15], s92 offen offset:128 lds
  s_waitcnt lgkmcnt(5)
  v_mfma_f32_32x32x16_bf16 v[156:171], v[24:27], v[60:63], v[156:171]
  v_mfma_f32_32x32x16_bf16 v[172:187], v[28:31], v[60:63], v[172:187]
  ds_read_b128 v[68:71], v250 offset:16384
  ds_read_b64_tr_b16 v[16:17], v15 offset:4096
  ds_read_b64_tr_b16 v[18:19], v15 offset:4608
  ds_read_b64_tr_b16 v[20:21], v14 offset:61440
  ds_read_b64_tr_b16 v[22:23], v14 offset:61952
  s_add_u32 m0, s57, 49152
  s_nop 0
  buffer_load_dwordx4 v10, s[8:11], s68 offen lds
  s_waitcnt lgkmcnt(5)
  v_mfma_f32_32x32x16_bf16 v[156:171], v[32:35], v[64:67], v[156:171]
  v_mfma_f32_32x32x16_bf16 v[172:187], v[36:39], v[64:67], v[172:187]
  ds_read_b128 v[72:75], v251 offset:16384
  ds_read_b64_tr_b16 v[24:25], v15 offset:6144
  ds_read_b64_tr_b16 v[26:27], v15 offset:6656
  ds_read_b64_tr_b16 v[28:29], v14 offset:63488
  ds_read_b64_tr_b16 v[30:31], v14 offset:64000
  s_add_u32 m0, s57, 50176
  s_nop 0
  buffer_load_dwordx4 v11, s[8:11], s68 offen lds
  s_waitcnt vmcnt(2)
  s_barrier
  s_waitcnt lgkmcnt(5)
  v_mfma_f32_32x32x16_bf16 v[156:171], v[16:19], v[68:71], v[156:171]
  v_mfma_f32_32x32x16_bf16 v[172:187], v[20:23], v[68:71], v[172:187]
  ds_read_b128 v[76:79], v248 offset:32768
  ds_read_b64_tr_b16 v[32:33], v14 offset:49152
  ds_read_b64_tr_b16 v[34:35], v14 offset:49664
  ds_read_b64_tr_b16 v[36:37], v14 offset:40960
  ds_read_b64_tr_b16 v[38:39], v14 offset:41472
  s_add_u32 m0, s59, 98304
  s_nop 0
  buffer_load_dwordx4 v12, s[12:15], s93 offen lds
  s_waitcnt lgkmcnt(5)
  v_mfma_f32_32x32x16_bf16 v[156:171], v[24:27], v[72:75], v[156:171]
  v_mfma_f32_32x32x16_bf16 v[172:187], v[28:31], v[72:75], v[172:187]
  ds_read_b128 v[80:83], v249 offset:32768
  ds_read_b64_tr_b16 v[16:17], v14 offset:51200
  ds_read_b64_tr_b16 v[18:19], v14 offset:51712
  ds_read_b64_tr_b16 v[20:21], v14 offset:43008
  ds_read_b64_tr_b16 v[22:23], v14 offset:43520
  s_add_u32 m0, s59, 89984
  s_nop 0
  buffer_load_dwordx4 v12, s[12:15], s93 offen offset:128 lds
  s_waitcnt lgkmcnt(5)
  v_mfma_f32_32x32x16_bf16 v[156:171], v[32:35], v[76:79], v[156:171]
  v_mfma_f32_32x32x16_bf16 v[172:187], v[36:39], v[76:79], v[172:187]
  ds_read_b128 v[84:87], v250 offset:32768
  ds_read_b64_tr_b16 v[24:25], v14 offset:53248
  ds_read_b64_tr_b16 v[26:27], v14 offset:53760
  ds_read_b64_tr_b16 v[28:29], v14 offset:45056
  ds_read_b64_tr_b16 v[30:31], v14 offset:45568
  s_add_u32 m0, s57, 0
  s_nop 0
  buffer_load_dwordx4 v10, s[8:11], s69 offen lds
  s_waitcnt lgkmcnt(5)
  v_mfma_f32_32x32x16_bf16 v[156:171], v[16:19], v[80:83], v[156:171]
  v_mfma_f32_32x32x16_bf16 v[172:187], v[20:23], v[80:83], v[172:187]
  ds_read_b128 v[88:91], v251 offset:32768
  ds_read_b64_tr_b16 v[32:33], v14 offset:55296
  ds_read_b64_tr_b16 v[34:35], v14 offset:55808
  ds_read_b64_tr_b16 v[36:37], v14 offset:47104
  ds_read_b64_tr_b16 v[38:39], v14 offset:47616
  s_add_u32 m0, s57, 1024
  s_nop 0
  buffer_load_dwordx4 v11, s[8:11], s69 offen lds
  s_waitcnt vmcnt(2)
  s_barrier
  s_waitcnt lgkmcnt(5)
  v_mfma_f32_32x32x16_bf16 v[156:171], v[24:27], v[84:87], v[156:171]
  v_mfma_f32_32x32x16_bf16 v[172:187], v[28:31], v[84:87], v[172:187]
  ds_read_b128 v[92:95], v248 offset:49152
  ds_read_b64_tr_b16 v[16:17], v14 offset:32768
  ds_read_b64_tr_b16 v[18:19], v14 offset:33280
  ds_read_b64_tr_b16 v[20:21], v14 offset:24576
  ds_read_b64_tr_b16 v[22:23], v14 offset:25088
  s_add_u32 m0, s59, 81920
  s_nop 0
  buffer_load_dwordx4 v12, s[12:15], s94 offen lds
  s_waitcnt lgkmcnt(5)
  v_mfma_f32_32x32x16_bf16 v[156:171], v[32:35], v[88:91], v[156:171]
  v_mfma_f32_32x32x16_bf16 v[172:187], v[36:39], v[88:91], v[172:187]
  ds_read_b128 v[96:99], v249 offset:49152
  ds_read_b64_tr_b16 v[24:25], v14 offset:34816
  ds_read_b64_tr_b16 v[26:27], v14 offset:35328
  ds_read_b64_tr_b16 v[28:29], v14 offset:26624
  ds_read_b64_tr_b16 v[30:31], v14 offset:27136
  s_add_u32 m0, s59, 139136
  s_nop 0
  buffer_load_dwordx4 v12, s[12:15], s94 offen offset:128 lds
  s_waitcnt lgkmcnt(5)
  v_mfma_f32_32x32x16_bf16 v[156:171], v[16:19], v[92:95], v[156:171]
  v_mfma_f32_32x32x16_bf16 v[172:187], v[20:23], v[92:95], v[172:187]
  ds_read_b128 v[100:103], v250 offset:49152
  ds_read_b64_tr_b16 v[32:33], v14 offset:36864
  ds_read_b64_tr_b16 v[34:35], v14 offset:37376
  ds_read_b64_tr_b16 v[36:37], v14 offset:28672
  ds_read_b64_tr_b16 v[38:39], v14 offset:29184
  s_add_u32 m0, s57, 16384
  s_nop 0
  buffer_load_dwordx4 v10, s[8:11], s70 offen lds
  s_waitcnt lgkmcnt(5)
  v_mfma_f32_32x32x16_bf16 v[156:171], v[24:27], v[96:99], v[156:171]
  v_mfma_f32_32x32x16_bf16 v[172:187], v[28:31], v[96:99], v[172:187]
  ds_read_b128 v[104:107], v251 offset:49152
  ds_read_b64_tr_b16 v[16:17], v14 offset:38912
  ds_read_b64_tr_b16 v[18:19], v14 offset:39424
  ds_read_b64_tr_b16 v[20:21], v14 offset:30720
  ds_read_b64_tr_b16 v[22:23], v14 offset:31232
  s_add_u32 m0, s57, 17408
  s_nop 0
  buffer_load_dwordx4 v11, s[8:11], s70 offen lds
  s_waitcnt vmcnt(2)
  s_barrier
  s_waitcnt lgkmcnt(5)
  v_mfma_f32_32x32x16_bf16 v[156:171], v[32:35], v[100:103], v[156:171]
  v_mfma_f32_32x32x16_bf16 v[172:187], v[36:39], v[100:103], v[172:187]
  ds_read_b128 v[108:111], v248 offset:0
  ds_read_b64_tr_b16 v[24:25], v14 offset:16384
  ds_read_b64_tr_b16 v[26:27], v14 offset:16896
  ds_read_b64_tr_b16 v[28:29], v15 offset:8192
  ds_read_b64_tr_b16 v[30:31], v15 offset:8704
  s_add_u32 m0, s59, 122880
  s_nop 0
  buffer_load_dwordx4 v12, s[12:15], s95 offen lds
  s_waitcnt lgkmcnt(5)
  v_mfma_f32_32x32x16_bf16 v[156:171], v[16:19], v[104:107], v[156:171]
  v_mfma_f32_32x32x16_bf16 v[172:187], v[20:23], v[104:107], v[172:187]
  ds_read_b128 v[112:115], v249 offset:0
  ds_read_b64_tr_b16 v[32:33], v14 offset:18432
  ds_read_b64_tr_b16 v[34:35], v14 offset:18944
  ds_read_b64_tr_b16 v[36:37], v15 offset:10240
  ds_read_b64_tr_b16 v[38:39], v15 offset:10752
  s_add_u32 m0, s59, 130944
  s_nop 0
  buffer_load_dwordx4 v12, s[12:15], s95 offen offset:128 lds
  s_waitcnt lgkmcnt(5)
  v_mfma_f32_32x32x16_bf16 v[156:171], v[24:27], v[108:111], v[156:171]
  v_mfma_f32_32x32x16_bf16 v[172:187], v[28:31], v[108:111], v[172:187]
  ds_read_b128 v[116:119], v250 offset:0
  ds_read_b64_tr_b16 v[16:17], v14 offset:20480
  ds_read_b64_tr_b16 v[18:19], v14 offset:20992
  ds_read_b64_tr_b16 v[20:21], v15 offset:12288
  ds_read_b64_tr_b16 v[22:23], v15 offset:12800
  s_add_u32 m0, s57, 32768
  s_nop 0
  buffer_load_dwordx4 v10, s[8:11], s71 offen lds
  s_waitcnt lgkmcnt(5)
  v_mfma_f32_32x32x16_bf16 v[156:171], v[32:35], v[112:115], v[156:171]
  v_mfma_f32_32x32x16_bf16 v[172:187], v[36:39], v[112:115], v[172:187]
  ds_read_b128 v[120:123], v251 offset:0
  ds_read_b64_tr_b16 v[24:25], v14 offset:22528
  ds_read_b64_tr_b16 v[26:27], v14 offset:23040
  ds_read_b64_tr_b16 v[28:29], v15 offset:14336
  ds_read_b64_tr_b16 v[30:31], v15 offset:14848
  s_add_u32 m0, s57, 33792
  s_nop 0
  buffer_load_dwordx4 v11, s[8:11], s71 offen lds
  s_waitcnt vmcnt(2)
  s_barrier
  s_waitcnt lgkmcnt(5)
  v_mfma_f32_32x32x16_bf16 v[156:171], v[16:19], v[116:119], v[156:171]
  v_mfma_f32_32x32x16_bf16 v[172:187], v[20:23], v[116:119], v[172:187]
  ds_read_b128 v[124:127], v248 offset:16384
  ds_read_b64_tr_b16 v[32:33], v14 offset:57344
  ds_read_b64_tr_b16 v[34:35], v14 offset:57856
  ds_read_b64_tr_b16 v[36:37], v15 offset:0
  ds_read_b64_tr_b16 v[38:39], v15 offset:512
  s_add_u32 m0, s59, 65536
  s_nop 0
  buffer_load_dwordx4 v12, s[12:15], s96 offen lds
  s_waitcnt lgkmcnt(5)
  v_mfma_f32_32x32x16_bf16 v[156:171], v[24:27], v[120:123], v[156:171]
  v_mfma_f32_32x32x16_bf16 v[172:187], v[28:31], v[120:123], v[172:187]
  ds_read_b128 v[128:131], v249 offset:16384
  ds_read_b64_tr_b16 v[16:17], v14 offset:59392
  ds_read_b64_tr_b16 v[18:19], v14 offset:59904
  ds_read_b64_tr_b16 v[20:21], v15 offset:2048
  ds_read_b64_tr_b16 v[22:23], v15 offset:2560
  s_add_u32 m0, s59, 73600
  s_nop 0
  buffer_load_dwordx4 v12, s[12:15], s96 offen offset:128 lds
  s_waitcnt lgkmcnt(5)
  v_mfma_f32_32x32x16_bf16 v[156:171], v[32:35], v[124:127], v[156:171]
  v_mfma_f32_32x32x16_bf16 v[172:187], v[36:39], v[124:127], v[172:187]
  ds_read_b128 v[132:135], v250 offset:16384
  ds_read_b64_tr_b16 v[24:25], v14 offset:61440
  ds_read_b64_tr_b16 v[26:27], v14 offset:61952
  ds_read_b64_tr_b16 v[28:29], v15 offset:4096
  ds_read_b64_tr_b16 v[30:31], v15 offset:4608
  s_add_u32 m0, s59, 89856
  s_nop 0
  buffer_load_dwordx4 v12, s[12:15], s90 offen offset:256 lds
  s_waitcnt lgkmcnt(5)
  v_mfma_f32_32x32x16_bf16 v[156:171], v[16:19], v[128:131], v[156:171]
  v_mfma_f32_32x32x16_bf16 v[172:187], v[20:23], v[128:131], v[172:187]
  ds_read_b128 v[136:139], v251 offset:16384
  ds_read_b64_tr_b16 v[32:33], v14 offset:63488
  ds_read_b64_tr_b16 v[34:35], v14 offset:64000
  ds_read_b64_tr_b16 v[36:37], v15 offset:6144
  ds_read_b64_tr_b16 v[38:39], v15 offset:6656
  s_add_u32 m0, s59, 57088
  s_nop 0
  buffer_load_dwordx4 v12, s[12:15], s91 offen offset:256 lds
  s_waitcnt vmcnt(2)
  s_barrier
  s_waitcnt lgkmcnt(5)
  v_mfma_f32_32x32x16_bf16 v[156:171], v[24:27], v[132:135], v[156:171]
  v_mfma_f32_32x32x16_bf16 v[172:187], v[28:31], v[132:135], v[172:187]
  ds_read_b128 v[140:143], v248 offset:32768
  ds_read_b64_tr_b16 v[16:17], v14 offset:0
  ds_read_b64_tr_b16 v[18:19], v14 offset:512
  ds_read_b64_tr_b16 v[20:21], v14 offset:8192
  ds_read_b64_tr_b16 v[22:23], v14 offset:8704
  s_add_u32 m0, s59, 48896
  s_nop 0
  buffer_load_dwordx4 v12, s[12:15], s92 offen offset:256 lds
  s_waitcnt lgkmcnt(5)
  v_mfma_f32_32x32x16_bf16 v[156:171], v[32:35], v[136:139], v[156:171]
  v_mfma_f32_32x32x16_bf16 v[172:187], v[36:39], v[136:139], v[172:187]
  ds_read_b128 v[144:147], v249 offset:32768
  ds_read_b64_tr_b16 v[24:25], v14 offset:2048
  ds_read_b64_tr_b16 v[26:27], v14 offset:2560
  ds_read_b64_tr_b16 v[28:29], v14 offset:10240
  ds_read_b64_tr_b16 v[30:31], v14 offset:10752
  s_add_u32 m0, s59, 81664
  s_nop 0
  buffer_load_dwordx4 v12, s[12:15], s93 offen offset:256 lds
  s_waitcnt lgkmcnt(5)
  v_mfma_f32_32x32x16_bf16 v[156:171], v[16:19], v[140:143], v[156:171]
  v_mfma_f32_32x32x16_bf16 v[172:187], v[20:23], v[140:143], v[172:187]
  ds_read_b128 v[148:151], v250 offset:32768
  ds_read_b64_tr_b16 v[32:33], v14 offset:4096
  ds_read_b64_tr_b16 v[34:35], v14 offset:4608
  ds_read_b64_tr_b16 v[36:37], v14 offset:12288
  ds_read_b64_tr_b16 v[38:39], v14 offset:12800
  s_add_u32 m0, s59, 7936
  s_nop 0
  buffer_load_dwordx4 v12, s[12:15], s94 offen offset:256 lds
  s_waitcnt lgkmcnt(5)
  v_mfma_f32_32x32x16_bf16 v[156:171], v[24:27], v[144:147], v[156:171]
  v_mfma_f32_32x32x16_bf16 v[172:187], v[28:31], v[144:147], v[172:187]
  ds_read_b128 v[152:155], v251 offset:32768
  ds_read_b64_tr_b16 v[16:17], v14 offset:6144
  ds_read_b64_tr_b16 v[18:19], v14 offset:6656
  ds_read_b64_tr_b16 v[20:21], v14 offset:14336
  ds_read_b64_tr_b16 v[22:23], v14 offset:14848
  s_add_u32 m0, s59, 0
  s_add_u32 s50, s95, 256
  buffer_load_dwordx4 v12, s[12:15], s50 offen lds
  s_waitcnt lgkmcnt(5)
  v_mfma_f32_32x32x16_bf16 v[156:171], v[32:35], v[148:151], v[156:171]
  v_mfma_f32_32x32x16_bf16 v[172:187], v[36:39], v[148:151], v[172:187]
  s_waitcnt lgkmcnt(0)
  v_mfma_f32_32x32x16_bf16 v[156:171], v[16:19], v[152:155], v[156:171]
  v_mfma_f32_32x32x16_bf16 v[172:187], v[20:23], v[152:155], v[172:187]
  v_mov_b32 v1, 0
  buffer_load_dword v43, v1, s[32:35], 0 offen sc1
  v_lshlrev_b32 v244, 4, v0
  v_lshrrev_b32 v1, 3, v0
  v_and_b32 v2, 7, v0
  v_lshrrev_b32 v3, 1, v1
  v_and_b32 v3, 1, v3
  v_lshlrev_b32 v3, 2, v3
  v_xor_b32 v2, v2, v3
  v_mul_u32_u24 v1, 896, v1
  v_lshl_add_u32 v245, v2, 4, v1
  s_lshr_b32 s50, s3, 2
  s_lshl_b32 s51, s46, 1
  s_add_u32 s51, s51, s50
  s_mul_i32 s51, s51, 144
  s_and_b32 s52, s3, 3
  s_add_u32 s51, s51, s52
  s_lshl_b32 s84, s51, 10
  s_lshl_b32 s53, s47, 7
  s_mul_i32 s51, s3, 7168
  s_add_u32 s85, s51, s53
  s_mul_i32 s51, s50, 28
  s_lshl_b32 s52, s52, 3
  s_add_u32 s51, s51, s52
  s_mul_i32 s51, s51, 896
  s_add_u32 s86, s51, s53
  s_lshl_b32 s87, s3, 10
  s_and_b32 s51, s3, 1
  s_lshl_b32 s51, s51, 2
  s_lshl_b32 s52, s50, 1
  s_add_u32 s51, s51, s52
  s_lshl_b32 s51, s51, 10
  v_add_u32 v246, s51, v244
  v_lshrrev_b32 v1, 5, v0
  v_lshlrev_b32 v1, 2, v1
  v_bfe_u32 v2, v0, 2, 2
  v_add_u32 v1, v1, v2
  v_lshlrev_b32 v1, 7, v1
  v_bfe_u32 v3, v0, 4, 1
  v_lshlrev_b32 v3, 1, v3
  v_bfe_u32 v4, v0, 1, 1
  v_add_u32 v3, v3, v4
  v_lshrrev_b32 v2, 1, v2
  v_lshlrev_b32 v2, 2, v2
  s_lshr_b32 s51, s3, 1
  s_and_b32 s51, s51, 1
  s_lshl_b32 s51, s51, 2
  v_add_u32 v3, s51, v3
  v_xor_b32 v3, v3, v2
  v_lshl_add_u32 v1, v3, 4, v1
  v_and_b32 v4, 1, v0
  v_lshl_add_u32 v1, v4, 3, v1
  s_lshl_b32 s51, s50, 12
  v_add_u32 v247, s51, v1
  v_add_u32 v249, 0x10000, v247
  v_add_u32 v246, 98304, v246
  s_and_b32 s50, s46, 3
  s_lshl_b32 s51, s50, 2
  s_lshl_b32 s52, s47, 1
  s_add_u32 s51, s51, s52
  s_mul_i32 s50, s50, 3
  s_add_u32 s50, s50, s47
  s_add_u32 s50, s50, 8
  v_add_u32 v1, s51, v0
  v_and_b32 v1, 15, v1
  v_lshrrev_b32 v2, 2, v1
  v_mul_u32_u24 v2, 7, v2
  v_and_b32 v3, 3, v1
  v_add_u32 v2, v2, v3
  v_and_b32 v3, 2, v1
  v_add_u32 v2, v2, v3
  v_add_u32 v1, s50, v0
  v_subrev_u32 v1, 24, v1
  v_mul_u32_u24 v3, 43, v1
  v_lshrrev_b32 v3, 9, v3
  v_mul_u32_u24 v3, 12, v3
  v_sub_u32 v1, v1, v3
  v_mul_u32_u24 v3, 43, v1
  v_lshrrev_b32 v3, 7, v3
  v_mul_u32_u24 v4, 3, v3
  v_sub_u32 v4, v1, v4
  v_mul_u32_u24 v3, 7, v3
  v_add_u32 v3, v3, v4
  v_and_b32 v4, 2, v4
  v_add_u32 v3, v3, v4
  v_add_u32 v3, 2, v3
  v_cmp_gt_u32 vcc, 16, v0
  s_nop 1
  v_cndmask_b32 v2, v3, v2, vcc
  v_mul_u32_u24 v250, 57344, v2
  v_add_u32 v250, s85, v250
  v_lshlrev_b32 v251, 12, v2
  v_add_u32 v251, s84, v251
  s_barrier
  s_add_u32 m0, s59, 73472
  s_nop 0
  buffer_load_dwordx4 v12, s[12:15], s96 offen offset:256 lds
  v_lshlrev_b32 v6, 4, v0
  s_mul_i32 s50, s49, 392
  s_mul_i32 s51, s3, 49
  s_add_u32 s50, s50, s51
  s_lshl_b32 s6, s50, 7
  s_mul_i32 s50, s49, 98
  s_mul_i32 s51, s3, 13
  s_add_u32 s50, s50, s51
  s_lshl_b32 s7, s50, 7
  v_min_u32 v8, 12, v0
  v_lshlrev_b32 v8, 7, v8
  s_waitcnt vmcnt(3)
  s_barrier
  ds_read_b64_tr_b16 v[16:17], v14 offset:24576
  ds_read_b64_tr_b16 v[18:19], v14 offset:25088
  ds_read_b64_tr_b16 v[20:21], v14 offset:26624
  ds_read_b64_tr_b16 v[22:23], v14 offset:27136
  ds_read_b64_tr_b16 v[24:25], v14 offset:28672
  ds_read_b64_tr_b16 v[26:27], v14 offset:29184
  ds_read_b64_tr_b16 v[28:29], v14 offset:30720
  ds_read_b64_tr_b16 v[30:31], v14 offset:31232
  ds_read_b64_tr_b16 v[32:33], v13 offset:57344
  ds_read_b64_tr_b16 v[34:35], v13 offset:57856
  ds_read_b64_tr_b16 v[36:37], v13 offset:59392
  ds_read_b64_tr_b16 v[38:39], v13 offset:59904
  s_waitcnt lgkmcnt(10)
  v_mfma_f32_32x32x16_bf16 v[188:203], v[16:19], v[44:47], 0
  ds_read_b64_tr_b16 v[16:17], v13 offset:61440
  ds_read_b64_tr_b16 v[18:19], v13 offset:61952
  v_mul_f32 v220, s63, v156
  s_add_u32 m0, s59, 147456
  s_nop 0
  buffer_load_dwordx4 v9, s[12:15], s90 offen lds
  v_mul_f32 v221, s63, v157
  v_mul_f32 v222, s63, v158
  s_add_u32 m0, s59, 139264
  s_nop 0
  buffer_load_dwordx4 v9, s[12:15], s91 offen lds
  v_mul_f32 v223, s63, v159
  v_mul_f32 v224, s63, v160
  s_waitcnt lgkmcnt(10)
  v_mfma_f32_32x32x16_bf16 v[188:203], v[20:23], v[48:51], v[188:203]
  ds_read_b64_tr_b16 v[20:21], v13 offset:63488
  ds_read_b64_tr_b16 v[22:23], v13 offset:64000
  s_add_u32 m0, s59, 131072
  s_nop 0
  buffer_load_dwordx4 v9, s[12:15], s92 offen lds
  v_mul_f32 v225, s63, v161
  v_mul_f32 v226, s63, v162
  s_add_u32 m0, s59, 122880
  s_nop 0
  buffer_load_dwordx4 v9, s[12:15], s93 offen lds
  v_mul_f32 v227, s63, v163
  v_mul_f32 v228, s63, v164
  s_add_u32 m0, s59, 114688
  s_nop 0
  buffer_load_dwordx4 v9, s[12:15], s94 offen lds
  s_waitcnt lgkmcnt(10)
  v_mfma_f32_32x32x16_bf16 v[188:203], v[24:27], v[52:55], v[188:203]
  ds_read_b64_tr_b16 v[24:25], v13 offset:49152
  ds_read_b64_tr_b16 v[26:27], v13 offset:49664
  v_mul_f32 v229, s63, v165
  v_mul_f32 v230, s63, v166
  s_add_u32 m0, s59, 106496
  s_nop 0
  buffer_load_dwordx4 v9, s[12:15], s95 offen lds
  v_mul_f32 v231, s63, v167
  v_mul_f32 v232, s63, v168
  s_add_u32 m0, s59, 98304
  s_nop 0
  buffer_load_dwordx4 v9, s[12:15], s96 offen lds
  v_mul_f32 v233, s63, v169
  s_waitcnt lgkmcnt(10)
  v_mfma_f32_32x32x16_bf16 v[188:203], v[28:31], v[56:59], v[188:203]
  ds_read_b64_tr_b16 v[28:29], v13 offset:51200
  ds_read_b64_tr_b16 v[30:31], v13 offset:51712
  v_mul_f32 v234, s63, v170
  v_mul_f32 v235, s63, v171
  v_exp_f32 v220, v220
  v_exp_f32 v221, v221
  v_exp_f32 v222, v222
  v_exp_f32 v223, v223
  v_exp_f32 v224, v224
  s_waitcnt lgkmcnt(10)
  v_mfma_f32_32x32x16_bf16 v[188:203], v[32:35], v[60:63], v[188:203]
  ds_read_b64_tr_b16 v[32:33], v13 offset:53248
  ds_read_b64_tr_b16 v[34:35], v13 offset:53760
  v_exp_f32 v225, v225
  v_exp_f32 v226, v226
  v_exp_f32 v227, v227
  v_exp_f32 v228, v228
  v_exp_f32 v229, v229
  v_exp_f32 v230, v230
  v_exp_f32 v231, v231
  s_waitcnt lgkmcnt(10)
  v_mfma_f32_32x32x16_bf16 v[188:203], v[36:39], v[64:67], v[188:203]
  ds_read_b64_tr_b16 v[36:37], v13 offset:55296
  ds_read_b64_tr_b16 v[38:39], v13 offset:55808
  v_exp_f32 v232, v232
  v_exp_f32 v233, v233
  s_add_u32 s51, s6, 0
  s_mov_b64 exec, 0x1fff
  buffer_load_dword v7, v8, s[16:19], s51 offen
  s_mov_b64 exec, -1
  v_exp_f32 v234, v234
  v_exp_f32 v235, v235
  v_add_f32 v220, 1.0, v220
  v_add_f32 v221, 1.0, v221
  s_waitcnt lgkmcnt(10)
  v_mfma_f32_32x32x16_bf16 v[188:203], v[16:19], v[68:71], v[188:203]
  ds_read_b64_tr_b16 v[16:17], v14 offset:16384
  ds_read_b64_tr_b16 v[18:19], v14 offset:16896
  v_add_f32 v222, 1.0, v222
  v_add_f32 v223, 1.0, v223
  v_add_f32 v224, 1.0, v224
  v_add_f32 v225, 1.0, v225
  v_add_f32 v226, 1.0, v226
  v_add_f32 v227, 1.0, v227
  v_add_f32 v228, 1.0, v228
  s_waitcnt lgkmcnt(10)
  v_mfma_f32_32x32x16_bf16 v[188:203], v[20:23], v[72:75], v[188:203]
  ds_read_b64_tr_b16 v[20:21], v14 offset:18432
  ds_read_b64_tr_b16 v[22:23], v14 offset:18944
  v_add_f32 v229, 1.0, v229
  v_add_f32 v230, 1.0, v230
  v_add_f32 v231, 1.0, v231
  v_add_f32 v232, 1.0, v232
  v_add_f32 v233, 1.0, v233
  v_add_f32 v234, 1.0, v234
  v_add_f32 v235, 1.0, v235
  s_waitcnt lgkmcnt(10)
  v_mfma_f32_32x32x16_bf16 v[188:203], v[24:27], v[76:79], v[188:203]
  ds_read_b64_tr_b16 v[24:25], v14 offset:20480
  ds_read_b64_tr_b16 v[26:27], v14 offset:20992
  v_rcp_f32 v220, v220
  v_rcp_f32 v221, v221
  v_rcp_f32 v222, v222
  v_rcp_f32 v223, v223
  v_rcp_f32 v224, v224
  s_add_u32 s51, s6, 1664
  s_mov_b64 exec, 0x1fff
  buffer_load_dword v7, v8, s[16:19], s51 offen
  s_mov_b64 exec, -1
  v_rcp_f32 v225, v225
  s_waitcnt lgkmcnt(10)
  v_mfma_f32_32x32x16_bf16 v[188:203], v[28:31], v[80:83], v[188:203]
  ds_read_b64_tr_b16 v[28:29], v14 offset:22528
  ds_read_b64_tr_b16 v[30:31], v14 offset:23040
  v_rcp_f32 v226, v226
  v_rcp_f32 v227, v227
  v_rcp_f32 v228, v228
  v_rcp_f32 v229, v229
  v_rcp_f32 v230, v230
  v_rcp_f32 v231, v231
  v_rcp_f32 v232, v232
  s_waitcnt lgkmcnt(10)
  v_mfma_f32_32x32x16_bf16 v[188:203], v[32:35], v[84:87], v[188:203]
  ds_read_b64_tr_b16 v[32:33], v13 offset:8192
  ds_read_b64_tr_b16 v[34:35], v13 offset:8704
  v_rcp_f32 v233, v233
  v_rcp_f32 v234, v234
  v_rcp_f32 v235, v235
  v_mul_f32 v220, v156, v220
  v_mul_f32 v221, v157, v221
  v_mul_f32 v222, v158, v222
  v_mul_f32 v223, v159, v223
  s_waitcnt lgkmcnt(10)
  v_mfma_f32_32x32x16_bf16 v[188:203], v[36:39], v[88:91], v[188:203]
  ds_read_b64_tr_b16 v[36:37], v13 offset:10240
  ds_read_b64_tr_b16 v[38:39], v13 offset:10752
  v_mul_f32 v224, v160, v224
  v_mul_f32 v225, v161, v225
  v_mul_f32 v226, v162, v226
  v_mul_f32 v227, v163, v227
  v_mul_f32 v228, v164, v228
  v_mul_f32 v229, v165, v229
  v_mul_f32 v230, v166, v230
  s_waitcnt lgkmcnt(10)
  v_mfma_f32_32x32x16_bf16 v[188:203], v[16:19], v[92:95], v[188:203]
  ds_read_b64_tr_b16 v[16:17], v13 offset:12288
  ds_read_b64_tr_b16 v[18:19], v13 offset:12800
  v_mul_f32 v231, v167, v231
  s_add_u32 s51, s6, 3328
  s_mov_b64 exec, 0x1fff
  buffer_load_dword v7, v8, s[16:19], s51 offen
  s_mov_b64 exec, -1
  v_mul_f32 v232, v168, v232
  v_mul_f32 v233, v169, v233
  v_mul_f32 v234, v170, v234
  v_mul_f32 v235, v171, v235
  v_cvt_pk_bf16_f32 v156, v220, v221
  s_waitcnt lgkmcnt(10)
  v_mfma_f32_32x32x16_bf16 v[188:203], v[20:23], v[96:99], v[188:203]
  ds_read_b64_tr_b16 v[20:21], v13 offset:14336
  ds_read_b64_tr_b16 v[22:23], v13 offset:14848
  v_cvt_pk_bf16_f32 v157, v222, v223
  v_cvt_pk_bf16_f32 v158, v224, v225
  v_cvt_pk_bf16_f32 v159, v226, v227
  v_cvt_pk_bf16_f32 v160, v228, v229
  v_cvt_pk_bf16_f32 v161, v230, v231
  v_cvt_pk_bf16_f32 v162, v232, v233
  v_cvt_pk_bf16_f32 v163, v234, v235
  s_waitcnt lgkmcnt(10)
  v_mfma_f32_32x32x16_bf16 v[188:203], v[24:27], v[100:103], v[188:203]
  s_waitcnt vmcnt(3)
  s_barrier
  ds_read_b64_tr_b16 v[24:25], v13 offset:0
  ds_read_b64_tr_b16 v[26:27], v13 offset:512
  v_mul_f32 v220, s63, v172
  v_mul_f32 v221, s63, v173
  v_mul_f32 v222, s63, v174
  v_mul_f32 v223, s63, v175
  v_mul_f32 v224, s63, v176
  v_mul_f32 v225, s63, v177
  v_mul_f32 v226, s63, v178
  s_waitcnt lgkmcnt(10)
  v_mfma_f32_32x32x16_bf16 v[188:203], v[28:31], v[104:107], v[188:203]
  ds_read_b64_tr_b16 v[28:29], v13 offset:2048
  ds_read_b64_tr_b16 v[30:31], v13 offset:2560
  v_mul_f32 v227, s63, v179
  v_mul_f32 v228, s63, v180
  v_mul_f32 v229, s63, v181
  v_mul_f32 v230, s63, v182
  s_add_u32 s51, s6, 4992
  s_mov_b64 exec, 0x1fff
  buffer_load_dword v7, v8, s[16:19], s51 offen
  s_mov_b64 exec, -1
  v_mul_f32 v231, s63, v183
  v_mul_f32 v232, s63, v184
  s_waitcnt lgkmcnt(10)
  v_mfma_f32_32x32x16_bf16 v[188:203], v[32:35], v[108:111], v[188:203]
  ds_read_b64_tr_b16 v[32:33], v13 offset:4096
  ds_read_b64_tr_b16 v[34:35], v13 offset:4608
  v_mul_f32 v233, s63, v185
  v_mul_f32 v234, s63, v186
  v_mul_f32 v235, s63, v187
  v_exp_f32 v220, v220
  v_exp_f32 v221, v221
  v_exp_f32 v222, v222
  v_exp_f32 v223, v223
  s_waitcnt lgkmcnt(10)
  v_mfma_f32_32x32x16_bf16 v[188:203], v[36:39], v[112:115], v[188:203]
  ds_read_b64_tr_b16 v[36:37], v13 offset:6144
  ds_read_b64_tr_b16 v[38:39], v13 offset:6656
  v_exp_f32 v224, v224
  v_exp_f32 v225, v225
  v_exp_f32 v226, v226
  v_exp_f32 v227, v227
  v_exp_f32 v228, v228
  v_exp_f32 v229, v229
  v_exp_f32 v230, v230
  s_waitcnt lgkmcnt(10)
  v_mfma_f32_32x32x16_bf16 v[188:203], v[16:19], v[116:119], v[188:203]
  ds_read_b64_tr_b16 v[16:17], v14 offset:8192
  ds_read_b64_tr_b16 v[18:19], v14 offset:8704
  v_exp_f32 v231, v231
  v_exp_f32 v232, v232
  v_exp_f32 v233, v233
  v_exp_f32 v234, v234
  v_exp_f32 v235, v235
  v_add_f32 v220, 1.0, v220
  v_add_f32 v221, 1.0, v221
  s_waitcnt lgkmcnt(10)
  v_mfma_f32_32x32x16_bf16 v[188:203], v[20:23], v[120:123], v[188:203]
  ds_read_b64_tr_b16 v[20:21], v14 offset:10240
  ds_read_b64_tr_b16 v[22:23], v14 offset:10752
  s_mov_b64 exec, 0x1fff
  buffer_load_dword v7, v8, s[20:23], s7 offen
  s_mov_b64 exec, -1
  v_add_f32 v222, 1.0, v222
  v_add_f32 v223, 1.0, v223
  v_add_f32 v224, 1.0, v224
  v_add_f32 v225, 1.0, v225
  v_add_f32 v226, 1.0, v226
  v_add_f32 v227, 1.0, v227
  s_waitcnt lgkmcnt(10)
  v_mfma_f32_32x32x16_bf16 v[188:203], v[24:27], v[124:127], v[188:203]
  ds_read_b64_tr_b16 v[24:25], v14 offset:12288
  ds_read_b64_tr_b16 v[26:27], v14 offset:12800
  v_add_f32 v228, 1.0, v228
  v_add_f32 v229, 1.0, v229
  v_add_f32 v230, 1.0, v230
  v_add_f32 v231, 1.0, v231
  v_add_f32 v232, 1.0, v232
  v_add_f32 v233, 1.0, v233
  v_add_f32 v234, 1.0, v234
  s_waitcnt lgkmcnt(10)
  v_mfma_f32_32x32x16_bf16 v[188:203], v[28:31], v[128:131], v[188:203]
  ds_read_b64_tr_b16 v[28:29], v14 offset:14336
  ds_read_b64_tr_b16 v[30:31], v14 offset:14848
  v_add_f32 v235, 1.0, v235
  v_rcp_f32 v220, v220
  v_rcp_f32 v221, v221
  v_rcp_f32 v222, v222
  v_rcp_f32 v223, v223
  v_rcp_f32 v224, v224
  v_rcp_f32 v225, v225
  s_waitcnt lgkmcnt(10)
  v_mfma_f32_32x32x16_bf16 v[188:203], v[32:35], v[132:135], v[188:203]
  v_rcp_f32 v226, v226
  v_rcp_f32 v227, v227
  v_rcp_f32 v228, v228
  v_rcp_f32 v229, v229
  v_rcp_f32 v230, v230
  v_rcp_f32 v231, v231
  v_rcp_f32 v232, v232
  s_waitcnt lgkmcnt(8)
  v_mfma_f32_32x32x16_bf16 v[188:203], v[36:39], v[136:139], v[188:203]
  v_rcp_f32 v233, v233
  v_rcp_f32 v234, v234
  v_rcp_f32 v235, v235
  v_mul_f32 v220, v172, v220
  v_mul_f32 v221, v173, v221
  v_mul_f32 v222, v174, v222
  v_mul_f32 v223, v175, v223
  s_waitcnt lgkmcnt(6)
  v_mfma_f32_32x32x16_bf16 v[188:203], v[16:19], v[140:143], v[188:203]
  v_mul_f32 v224, v176, v224
  v_mul_f32 v225, v177, v225
  v_mul_f32 v226, v178, v226
  v_mul_f32 v227, v179, v227
  v_mul_f32 v228, v180, v228
  v_mul_f32 v229, v181, v229
  v_mul_f32 v230, v182, v230
  s_waitcnt lgkmcnt(4)
  v_mfma_f32_32x32x16_bf16 v[188:203], v[20:23], v[144:147], v[188:203]
  v_mul_f32 v231, v183, v231
  v_mul_f32 v232, v184, v232
  v_mul_f32 v233, v185, v233
  v_mul_f32 v234, v186, v234
  v_mul_f32 v235, v187, v235
  v_cvt_pk_bf16_f32 v172, v220, v221
  v_cvt_pk_bf16_f32 v173, v222, v223
  s_waitcnt lgkmcnt(2)
  v_mfma_f32_32x32x16_bf16 v[188:203], v[24:27], v[148:151], v[188:203]
  v_cvt_pk_bf16_f32 v174, v224, v225
  v_cvt_pk_bf16_f32 v175, v226, v227
  v_cvt_pk_bf16_f32 v176, v228, v229
  v_cvt_pk_bf16_f32 v177, v230, v231
  v_cvt_pk_bf16_f32 v178, v232, v233
  v_cvt_pk_bf16_f32 v179, v234, v235
  s_waitcnt lgkmcnt(0)
  v_mfma_f32_32x32x16_bf16 v[188:203], v[28:31], v[152:155], v[188:203]
  v_readfirstlane_b32 s48, v43
  s_nop 0
  s_cmp_lg_u32 s48, 0
  s_nop 7
  s_cbranch_scc1 L_nd_2
  s_mov_b32 s88, 0x40000
  v_mov_b32 v1, 0
L_nq_1:
  buffer_load_dword v43, v1, s[32:35], 0 offen sc1
  s_waitcnt vmcnt(0)
  v_readfirstlane_b32 s48, v43
  s_sub_u32 s88, s88, 1
  s_cmp_eq_u32 s88, 0
  s_nop 1
  s_cbranch_scc1 L_nd_2
  s_cmp_eq_u32 s48, 0
  s_cbranch_scc1 L_nq_1
L_nd_2:
  s_barrier
  s_lshr_b32 s50, s3, 2
  s_cmp_lg_u32 s50, s74
  s_cbranch_scc1 L_ffn_idle_3
  ds_read_b64_tr_b16 v[16:17], v15 offset:16384
  ds_read_b64_tr_b16 v[18:19], v15 offset:16896
  ds_read_b64_tr_b16 v[20:21], v15 offset:18432
  ds_read_b64_tr_b16 v[22:23], v15 offset:18944
  ds_read_b64_tr_b16 v[24:25], v15 offset:20480
  ds_read_b64_tr_b16 v[26:27], v15 offset:20992
  ds_read_b64_tr_b16 v[28:29], v15 offset:22528
  ds_read_b64_tr_b16 v[30:31], v15 offset:23040
  ds_read_b64_tr_b16 v[32:33], v15 offset:8192
  ds_read_b64_tr_b16 v[34:35], v15 offset:8704
  ds_read_b64_tr_b16 v[36:37], v15 offset:10240
  ds_read_b64_tr_b16 v[38:39], v15 offset:10752
  s_waitcnt lgkmcnt(10)
  v_mfma_f32_32x32x16_bf16 v[204:219], v[16:19], v[44:47], 0
  ds_read_b64_tr_b16 v[16:17], v15 offset:12288
  ds_read_b64_tr_b16 v[18:19], v15 offset:12800
  s_add_u32 s53, s64, 0
  buffer_store_dwordx4 v[156:159], v6, s[24:27], s53 offen sc1
  s_add_u32 s53, s64, 1024
  buffer_store_dwordx4 v[160:163], v6, s[24:27], s53 offen sc1
  s_add_u32 s53, s64, 4096
  buffer_store_dwordx4 v[172:175], v6, s[24:27], s53 offen sc1
  s_add_u32 s53, s64, 5120
  buffer_store_dwordx4 v[176:179], v6, s[24:27], s53 offen sc1
  s_waitcnt lgkmcnt(10)
  v_mfma_f32_32x32x16_bf16 v[204:219], v[20:23], v[48:51], v[204:219]
  ds_read_b64_tr_b16 v[20:21], v15 offset:14336
  ds_read_b64_tr_b16 v[22:23], v15 offset:14848
  v_mul_f32 v220, s63, v188
  v_mul_f32 v221, s63, v189
  v_mul_f32 v222, s63, v190
  v_mul_f32 v223, s63, v191
  s_waitcnt lgkmcnt(10)
  v_mfma_f32_32x32x16_bf16 v[204:219], v[24:27], v[52:55], v[204:219]
  ds_read_b64_tr_b16 v[24:25], v15 offset:0
  ds_read_b64_tr_b16 v[26:27], v15 offset:512
  v_mul_f32 v224, s63, v192
  v_mul_f32 v225, s63, v193
  v_mul_f32 v226, s63, v194
  v_mul_f32 v227, s63, v195
  s_waitcnt lgkmcnt(10)
  v_mfma_f32_32x32x16_bf16 v[204:219], v[28:31], v[56:59], v[204:219]
  ds_read_b64_tr_b16 v[28:29], v15 offset:2048
  ds_read_b64_tr_b16 v[30:31], v15 offset:2560
  v_mul_f32 v228, s63, v196
  v_mul_f32 v229, s63, v197
  v_mul_f32 v230, s63, v198
  v_mul_f32 v231, s63, v199
  s_waitcnt lgkmcnt(10)
  v_mfma_f32_32x32x16_bf16 v[204:219], v[32:35], v[60:63], v[204:219]
  ds_read_b64_tr_b16 v[32:33], v15 offset:4096
  ds_read_b64_tr_b16 v[34:35], v15 offset:4608
  v_mul_f32 v232, s63, v200
  v_mul_f32 v233, s63, v201
  v_mul_f32 v234, s63, v202
  v_mul_f32 v235, s63, v203
  s_waitcnt lgkmcnt(10)
  v_mfma_f32_32x32x16_bf16 v[204:219], v[36:39], v[64:67], v[204:219]
  ds_read_b64_tr_b16 v[36:37], v15 offset:6144
  ds_read_b64_tr_b16 v[38:39], v15 offset:6656
  v_exp_f32 v220, v220
  v_exp_f32 v221, v221
  v_exp_f32 v222, v222
  v_exp_f32 v223, v223
  s_waitcnt lgkmcnt(10)
  v_mfma_f32_32x32x16_bf16 v[204:219], v[16:19], v[68:71], v[204:219]
  ds_read_b64_tr_b16 v[16:17], v14 offset:57344
  ds_read_b64_tr_b16 v[18:19], v14 offset:57856
  v_exp_f32 v224, v224
  v_exp_f32 v225, v225
  v_exp_f32 v226, v226
  v_exp_f32 v227, v227
  s_waitcnt lgkmcnt(10)
  v_mfma_f32_32x32x16_bf16 v[204:219], v[20:23], v[72:75], v[204:219]
  ds_read_b64_tr_b16 v[20:21], v14 offset:59392
  ds_read_b64_tr_b16 v[22:23], v14 offset:59904
  v_exp_f32 v228, v228
  v_exp_f32 v229, v229
  v_exp_f32 v230, v230
  v_exp_f32 v231, v231
  s_waitcnt lgkmcnt(10)
  v_mfma_f32_32x32x16_bf16 v[204:219], v[24:27], v[76:79], v[204:219]
  ds_read_b64_tr_b16 v[24:25], v14 offset:61440
  ds_read_b64_tr_b16 v[26:27], v14 offset:61952
  v_exp_f32 v232, v232
  v_exp_f32 v233, v233
  v_exp_f32 v234, v234
  v_exp_f32 v235, v235
  s_waitcnt lgkmcnt(10)
  v_mfma_f32_32x32x16_bf16 v[204:219], v[28:31], v[80:83], v[204:219]
  ds_read_b64_tr_b16 v[28:29], v14 offset:63488
  ds_read_b64_tr_b16 v[30:31], v14 offset:64000
  v_add_f32 v220, 1.0, v220
  v_add_f32 v221, 1.0, v221
  v_add_f32 v222, 1.0, v222
  v_add_f32 v223, 1.0, v223
  s_waitcnt lgkmcnt(10)
  v_mfma_f32_32x32x16_bf16 v[204:219], v[32:35], v[84:87], v[204:219]
  ds_read_b64_tr_b16 v[32:33], v14 offset:49152
  ds_read_b64_tr_b16 v[34:35], v14 offset:49664
  v_add_f32 v224, 1.0, v224
  v_add_f32 v225, 1.0, v225
  v_add_f32 v226, 1.0, v226
  v_add_f32 v227, 1.0, v227
  s_waitcnt lgkmcnt(10)
  v_mfma_f32_32x32x16_bf16 v[204:219], v[36:39], v[88:91], v[204:219]
  ds_read_b64_tr_b16 v[36:37], v14 offset:51200
  ds_read_b64_tr_b16 v[38:39], v14 offset:51712
  v_add_f32 v228, 1.0, v228
  v_add_f32 v229, 1.0, v229
  v_add_f32 v230, 1.0, v230
  v_add_f32 v231, 1.0, v231
  s_waitcnt lgkmcnt(10)
  v_mfma_f32_32x32x16_bf16 v[204:219], v[16:19], v[92:95], v[204:219]
  ds_read_b64_tr_b16 v[16:17], v14 offset:53248
  ds_read_b64_tr_b16 v[18:19], v14 offset:53760
  v_add_f32 v232, 1.0, v232
  v_add_f32 v233, 1.0, v233
  v_add_f32 v234, 1.0, v234
  v_add_f32 v235, 1.0, v235
  s_waitcnt lgkmcnt(10)
  v_mfma_f32_32x32x16_bf16 v[204:219], v[20:23], v[96:99], v[204:219]
  ds_read_b64_tr_b16 v[20:21], v14 offset:55296
  ds_read_b64_tr_b16 v[22:23], v14 offset:55808
  v_rcp_f32 v220, v220
  v_rcp_f32 v221, v221
  v_rcp_f32 v222, v222
  v_rcp_f32 v223, v223
  s_waitcnt lgkmcnt(10)
  v_mfma_f32_32x32x16_bf16 v[204:219], v[24:27], v[100:103], v[204:219]
  ds_read_b64_tr_b16 v[24:25], v14 offset:40960
  ds_read_b64_tr_b16 v[26:27], v14 offset:41472
  v_rcp_f32 v224, v224
  v_rcp_f32 v225, v225
  v_rcp_f32 v226, v226
  v_rcp_f32 v227, v227
  s_waitcnt lgkmcnt(10)
  v_mfma_f32_32x32x16_bf16 v[204:219], v[28:31], v[104:107], v[204:219]
  ds_read_b64_tr_b16 v[28:29], v14 offset:43008
  ds_read_b64_tr_b16 v[30:31], v14 offset:43520
  s_waitcnt vmcnt(0)
  s_barrier
  s_lshl_b32 s51, s44, 7
  s_lshl_b32 s52, s45, 4
  s_add_u32 s51, s51, s52
  s_add_u32 s51, s51, 13631488
  s_cmp_lg_u32 s3, 0
  s_nop 1
  s_cbranch_scc1 L_nohf_5
  v_mov_b32 v2, s48
  v_mov_b32 v3, s48
  v_mov_b32 v4, 0
  s_mov_b64 exec, 1
  buffer_store_dwordx2 v[2:3], v4, s[24:27], s51 offen sc1
  s_mov_b64 exec, -1
L_nohf_5:
  v_rcp_f32 v228, v228
  v_rcp_f32 v229, v229
  v_rcp_f32 v230, v230
  s_waitcnt lgkmcnt(10)
  v_mfma_f32_32x32x16_bf16 v[204:219], v[32:35], v[108:111], v[204:219]
  ds_read_b64_tr_b16 v[32:33], v14 offset:45056
  ds_read_b64_tr_b16 v[34:35], v14 offset:45568
  v_rcp_f32 v231, v231
  v_rcp_f32 v232, v232
  v_rcp_f32 v233, v233
  v_rcp_f32 v234, v234
  s_waitcnt lgkmcnt(10)
  v_mfma_f32_32x32x16_bf16 v[204:219], v[36:39], v[112:115], v[204:219]
  ds_read_b64_tr_b16 v[36:37], v14 offset:47104
  ds_read_b64_tr_b16 v[38:39], v14 offset:47616
  v_rcp_f32 v235, v235
  v_mul_f32 v220, v188, v220
  v_mul_f32 v221, v189, v221
  v_mul_f32 v222, v190, v222
  s_waitcnt lgkmcnt(10)
  v_mfma_f32_32x32x16_bf16 v[204:219], v[16:19], v[116:119], v[204:219]
  ds_read_b64_tr_b16 v[16:17], v14 offset:32768
  ds_read_b64_tr_b16 v[18:19], v14 offset:33280
  v_mul_f32 v223, v191, v223
  v_mul_f32 v224, v192, v224
  v_mul_f32 v225, v193, v225
  v_mul_f32 v226, v194, v226
  s_waitcnt lgkmcnt(10)
  v_mfma_f32_32x32x16_bf16 v[204:219], v[20:23], v[120:123], v[204:219]
  ds_read_b64_tr_b16 v[20:21], v14 offset:34816
  ds_read_b64_tr_b16 v[22:23], v14 offset:35328
  v_mul_f32 v227, v195, v227
  v_mul_f32 v228, v196, v228
  v_mul_f32 v229, v197, v229
  v_mul_f32 v230, v198, v230
  s_waitcnt lgkmcnt(10)
  v_mfma_f32_32x32x16_bf16 v[204:219], v[24:27], v[124:127], v[204:219]
  ds_read_b64_tr_b16 v[24:25], v14 offset:36864
  ds_read_b64_tr_b16 v[26:27], v14 offset:37376
  v_mul_f32 v231, v199, v231
  v_mul_f32 v232, v200, v232
  v_mul_f32 v233, v201, v233
  v_mul_f32 v234, v202, v234
  s_waitcnt lgkmcnt(10)
  v_mfma_f32_32x32x16_bf16 v[204:219], v[28:31], v[128:131], v[204:219]
  ds_read_b64_tr_b16 v[28:29], v14 offset:38912
  ds_read_b64_tr_b16 v[30:31], v14 offset:39424
  v_mul_f32 v235, v203, v235
  v_cvt_pk_bf16_f32 v236, v220, v221
  v_cvt_pk_bf16_f32 v237, v222, v223
  v_cvt_pk_bf16_f32 v238, v224, v225
  s_waitcnt lgkmcnt(10)
  v_mfma_f32_32x32x16_bf16 v[204:219], v[32:35], v[132:135], v[204:219]
  v_cvt_pk_bf16_f32 v239, v226, v227
  v_cvt_pk_bf16_f32 v240, v228, v229
  v_cvt_pk_bf16_f32 v241, v230, v231
  v_cvt_pk_bf16_f32 v242, v232, v233
  s_waitcnt lgkmcnt(8)
  v_mfma_f32_32x32x16_bf16 v[204:219], v[36:39], v[136:139], v[204:219]
  v_cvt_pk_bf16_f32 v243, v234, v235
  s_add_u32 s53, s64, 8192
  buffer_store_dwordx4 v[236:239], v6, s[24:27], s53 offen sc1
  s_add_u32 s53, s64, 9216
  buffer_store_dwordx4 v[240:243], v6, s[24:27], s53 offen sc1
  s_waitcnt lgkmcnt(6)
  v_mfma_f32_32x32x16_bf16 v[204:219], v[16:19], v[140:143], v[204:219]
  s_waitcnt lgkmcnt(4)
  v_mfma_f32_32x32x16_bf16 v[204:219], v[20:23], v[144:147], v[204:219]
  s_waitcnt lgkmcnt(2)
  v_mfma_f32_32x32x16_bf16 v[204:219], v[24:27], v[148:151], v[204:219]
  s_waitcnt lgkmcnt(0)
  v_mfma_f32_32x32x16_bf16 v[204:219], v[28:31], v[152:155], v[204:219]
  s_nop 11
  v_mul_f32 v220, s63, v204
  v_mul_f32 v221, s63, v205
  v_mul_f32 v222, s63, v206
  v_mul_f32 v223, s63, v207
  v_mul_f32 v224, s63, v208
  v_mul_f32 v225, s63, v209
  v_mul_f32 v226, s63, v210
  v_mul_f32 v227, s63, v211
  v_mul_f32 v228, s63, v212
  v_mul_f32 v229, s63, v213
  v_mul_f32 v230, s63, v214
  v_mul_f32 v231, s63, v215
  v_mul_f32 v232, s63, v216
  v_mul_f32 v233, s63, v217
  v_mul_f32 v234, s63, v218
  v_mul_f32 v235, s63, v219
  v_exp_f32 v220, v220
  v_exp_f32 v221, v221
  v_exp_f32 v222, v222
  v_exp_f32 v223, v223
  v_exp_f32 v224, v224
  v_exp_f32 v225, v225
  v_exp_f32 v226, v226
  v_exp_f32 v227, v227
  v_exp_f32 v228, v228
  v_exp_f32 v229, v229
  v_exp_f32 v230, v230
  v_exp_f32 v231, v231
  v_exp_f32 v232, v232
  v_exp_f32 v233, v233
  v_exp_f32 v234, v234
  v_exp_f32 v235, v235
  v_add_f32 v220, 1.0, v220
  v_add_f32 v221, 1.0, v221
  v_add_f32 v222, 1.0, v222
  v_add_f32 v223, 1.0, v223
  v_add_f32 v224, 1.0, v224
  v_add_f32 v225, 1.0, v225
  v_add_f32 v226, 1.0, v226
  v_add_f32 v227, 1.0, v227
  v_add_f32 v228, 1.0, v228
  v_add_f32 v229, 1.0, v229
  v_add_f32 v230, 1.0, v230
  v_add_f32 v231, 1.0, v231
  v_add_f32 v232, 1.0, v232
  v_add_f32 v233, 1.0, v233
  v_add_f32 v234, 1.0, v234
  v_add_f32 v235, 1.0, v235
  v_rcp_f32 v220, v220
  v_rcp_f32 v221, v221
  v_rcp_f32 v222, v222
  v_rcp_f32 v223, v223
  v_rcp_f32 v224, v224
  v_rcp_f32 v225, v225
  v_rcp_f32 v226, v226
  v_rcp_f32 v227, v227
  v_rcp_f32 v228, v228
  v_rcp_f32 v229, v229
  v_rcp_f32 v230, v230
  v_rcp_f32 v231, v231
  v_rcp_f32 v232, v232
  v_rcp_f32 v233, v233
  v_rcp_f32 v234, v234
  v_rcp_f32 v235, v235
  v_mul_f32 v220, v204, v220
  v_mul_f32 v221, v205, v221
  v_mul_f32 v222, v206, v222
  v_mul_f32 v223, v207, v223
  v_mul_f32 v224, v208, v224
  v_mul_f32 v225, v209, v225
  v_mul_f32 v226, v210, v226
  v_mul_f32 v227, v211, v227
  v_mul_f32 v228, v212, v228
  v_mul_f32 v229, v213, v229
  v_mul_f32 v230, v214, v230
  v_mul_f32 v231, v215, v231
  v_mul_f32 v232, v216, v232
  v_mul_f32 v233, v217, v233
  v_mul_f32 v234, v218, v234
  v_mul_f32 v235, v219, v235
  v_cvt_pk_bf16_f32 v236, v220, v221
  v_cvt_pk_bf16_f32 v237, v222, v223
  v_cvt_pk_bf16_f32 v238, v224, v225
  v_cvt_pk_bf16_f32 v239, v226, v227
  v_cvt_pk_bf16_f32 v240, v228, v229
  v_cvt_pk_bf16_f32 v241, v230, v231
  v_cvt_pk_bf16_f32 v242, v232, v233
  v_cvt_pk_bf16_f32 v243, v234, v235
  s_add_u32 s53, s72, 0
  buffer_store_dwordx4 v[236:239], v6, s[24:27], s53 offen sc1
  s_add_u32 s53, s72, 1024
  buffer_store_dwordx4 v[240:243], v6, s[24:27], s53 offen sc1
  s_branch L_ffn_join_4
L_ffn_idle_3:
  s_add_u32 s53, s64, 0
  buffer_store_dwordx4 v[156:159], v6, s[24:27], s53 offen sc1
  s_add_u32 s53, s64, 1024
  buffer_store_dwordx4 v[160:163], v6, s[24:27], s53 offen sc1
  s_add_u32 s53, s64, 4096
  buffer_store_dwordx4 v[172:175], v6, s[24:27], s53 offen sc1
  s_add_u32 s53, s64, 5120
  buffer_store_dwordx4 v[176:179], v6, s[24:27], s53 offen sc1
  v_mul_f32 v220, s63, v188
  v_mul_f32 v221, s63, v189
  v_mul_f32 v222, s63, v190
  v_mul_f32 v223, s63, v191
  v_mul_f32 v224, s63, v192
  v_mul_f32 v225, s63, v193
  v_mul_f32 v226, s63, v194
  v_mul_f32 v227, s63, v195
  v_mul_f32 v228, s63, v196
  v_mul_f32 v229, s63, v197
  v_mul_f32 v230, s63, v198
  v_mul_f32 v231, s63, v199
  v_mul_f32 v232, s63, v200
  v_mul_f32 v233, s63, v201
  v_mul_f32 v234, s63, v202
  v_mul_f32 v235, s63, v203
  v_exp_f32 v220, v220
  v_exp_f32 v221, v221
  v_exp_f32 v222, v222
  v_exp_f32 v223, v223
  v_exp_f32 v224, v224
  v_exp_f32 v225, v225
  v_exp_f32 v226, v226
  v_exp_f32 v227, v227
  v_exp_f32 v228, v228
  v_exp_f32 v229, v229
  v_exp_f32 v230, v230
  v_exp_f32 v231, v231
  v_exp_f32 v232, v232
  v_exp_f32 v233, v233
  v_exp_f32 v234, v234
  v_exp_f32 v235, v235
  v_add_f32 v220, 1.0, v220
  v_add_f32 v221, 1.0, v221
  v_add_f32 v222, 1.0, v222
  v_add_f32 v223, 1.0, v223
  v_add_f32 v224, 1.0, v224
  v_add_f32 v225, 1.0, v225
  v_add_f32 v226, 1.0, v226
  v_add_f32 v227, 1.0, v227
  v_add_f32 v228, 1.0, v228
  v_add_f32 v229, 1.0, v229
  v_add_f32 v230, 1.0, v230
  v_add_f32 v231, 1.0, v231
  v_add_f32 v232, 1.0, v232
  v_add_f32 v233, 1.0, v233
  v_add_f32 v234, 1.0, v234
  v_add_f32 v235, 1.0, v235
  v_rcp_f32 v220, v220
  v_rcp_f32 v221, v221
  v_rcp_f32 v222, v222
  v_rcp_f32 v223, v223
  v_rcp_f32 v224, v224
  v_rcp_f32 v225, v225
  v_rcp_f32 v226, v226
  v_rcp_f32 v227, v227
  v_rcp_f32 v228, v228
  v_rcp_f32 v229, v229
  v_rcp_f32 v230, v230
  v_rcp_f32 v231, v231
  v_rcp_f32 v232, v232
  v_rcp_f32 v233, v233
  v_rcp_f32 v234, v234
  v_rcp_f32 v235, v235
  v_mul_f32 v220, v188, v220
  v_mul_f32 v221, v189, v221
  v_mul_f32 v222, v190, v222
  v_mul_f32 v223, v191, v223
  v_mul_f32 v224, v192, v224
  v_mul_f32 v225, v193, v225
  v_mul_f32 v226, v194, v226
  v_mul_f32 v227, v195, v227
  v_mul_f32 v228, v196, v228
  v_mul_f32 v229, v197, v229
  v_mul_f32 v230, v198, v230
  v_mul_f32 v231, v199, v231
  s_waitcnt vmcnt(0)
  s_barrier
  s_lshl_b32 s51, s44, 7
  s_lshl_b32 s52, s45, 4
  s_add_u32 s51, s51, s52
  s_add_u32 s51, s51, 13631488
  s_cmp_lg_u32 s3, 0
  s_cbranch_scc1 L_nohf_6
  v_mov_b32 v2, s48
  v_mov_b32 v3, s48
  v_mov_b32 v4, 0
  s_mov_b64 exec, 1
  buffer_store_dwordx2 v[2:3], v4, s[24:27], s51 offen sc1
  s_mov_b64 exec, -1
L_nohf_6:
  v_mul_f32 v232, v200, v232
  v_mul_f32 v233, v201, v233
  v_mul_f32 v234, v202, v234
  v_mul_f32 v235, v203, v235
  v_cvt_pk_bf16_f32 v236, v220, v221
  v_cvt_pk_bf16_f32 v237, v222, v223
  v_cvt_pk_bf16_f32 v238, v224, v225
  v_cvt_pk_bf16_f32 v239, v226, v227
  v_cvt_pk_bf16_f32 v240, v228, v229
  v_cvt_pk_bf16_f32 v241, v230, v231
  v_cvt_pk_bf16_f32 v242, v232, v233
  v_cvt_pk_bf16_f32 v243, v234, v235
  s_add_u32 s53, s64, 8192
  buffer_store_dwordx4 v[236:239], v6, s[24:27], s53 offen sc1
  s_add_u32 s53, s64, 9216
  buffer_store_dwordx4 v[240:243], v6, s[24:27], s53 offen sc1
  s_cmp_lg_u32 s45, 0
  s_cbranch_scc1 L_nogate_7
  v_add_u32 v1, s65, v252
  ds_read_b128 v[16:19], v1 offset:0
  ds_read_b128 v[20:23], v1 offset:32
  ds_read_b128 v[24:27], v1 offset:64
  ds_read_b128 v[28:31], v1 offset:96
  v_add_u32 v1, s66, v252
  ds_read_b128 v[32:35], v1 offset:0
  ds_read_b128 v[36:39], v1 offset:32
  s_waitcnt lgkmcnt(5)
  v_mfma_f32_32x32x16_bf16 v[204:219], v[16:19], v[44:47], 0
  ds_read_b128 v[16:19], v1 offset:64
  s_waitcnt lgkmcnt(5)
  v_mfma_f32_32x32x16_bf16 v[204:219], v[20:23], v[48:51], v[204:219]
  ds_read_b128 v[20:23], v1 offset:96
  s_waitcnt lgkmcnt(5)
  v_mfma_f32_32x32x16_bf16 v[204:219], v[24:27], v[52:55], v[204:219]
  v_add_u32 v1, s67, v252
  ds_read_b128 v[24:27], v1 offset:0
  s_waitcnt lgkmcnt(5)
  v_mfma_f32_32x32x16_bf16 v[204:219], v[28:31], v[56:59], v[204:219]
  ds_read_b128 v[28:31], v1 offset:32
  s_waitcnt lgkmcnt(5)
  v_mfma_f32_32x32x16_bf16 v[204:219], v[32:35], v[60:63], v[204:219]
  ds_read_b128 v[32:35], v1 offset:64
  s_waitcnt lgkmcnt(5)
  v_mfma_f32_32x32x16_bf16 v[204:219], v[36:39], v[64:67], v[204:219]
  ds_read_b128 v[36:39], v1 offset:96
  s_waitcnt lgkmcnt(5)
  v_mfma_f32_32x32x16_bf16 v[204:219], v[16:19], v[68:71], v[204:219]
  v_add_u32 v1, s68, v252
  ds_read_b128 v[16:19], v1 offset:0
  s_waitcnt lgkmcnt(5)
  v_mfma_f32_32x32x16_bf16 v[204:219], v[20:23], v[72:75], v[204:219]
  ds_read_b128 v[20:23], v1 offset:32
  s_waitcnt lgkmcnt(5)
  v_mfma_f32_32x32x16_bf16 v[204:219], v[24:27], v[76:79], v[204:219]
  ds_read_b128 v[24:27], v1 offset:64
  s_waitcnt lgkmcnt(5)
  v_mfma_f32_32x32x16_bf16 v[204:219], v[28:31], v[80:83], v[204:219]
  ds_read_b128 v[28:31], v1 offset:96
  s_waitcnt lgkmcnt(5)
  v_mfma_f32_32x32x16_bf16 v[204:219], v[32:35], v[84:87], v[204:219]
  v_add_u32 v1, s69, v252
  ds_read_b128 v[32:35], v1 offset:0
  s_waitcnt lgkmcnt(5)
  v_mfma_f32_32x32x16_bf16 v[204:219], v[36:39], v[88:91], v[204:219]
  ds_read_b128 v[36:39], v1 offset:32
  s_waitcnt lgkmcnt(5)
  v_mfma_f32_32x32x16_bf16 v[204:219], v[16:19], v[92:95], v[204:219]
  ds_read_b128 v[16:19], v1 offset:64
  s_waitcnt lgkmcnt(5)
  v_mfma_f32_32x32x16_bf16 v[204:219], v[20:23], v[96:99], v[204:219]
  ds_read_b128 v[20:23], v1 offset:96
  s_waitcnt lgkmcnt(5)
  v_mfma_f32_32x32x16_bf16 v[204:219], v[24:27], v[100:103], v[204:219]
  v_add_u32 v1, s70, v252
  ds_read_b128 v[24:27], v1 offset:0
  s_waitcnt lgkmcnt(5)
  v_mfma_f32_32x32x16_bf16 v[204:219], v[28:31], v[104:107], v[204:219]
  ds_read_b128 v[28:31], v1 offset:32
  s_waitcnt lgkmcnt(5)
  v_mfma_f32_32x32x16_bf16 v[204:219], v[32:35], v[108:111], v[204:219]
  ds_read_b128 v[32:35], v1 offset:64
  s_waitcnt lgkmcnt(5)
  v_mfma_f32_32x32x16_bf16 v[204:219], v[36:39], v[112:115], v[204:219]
  ds_read_b128 v[36:39], v1 offset:96
  s_waitcnt lgkmcnt(5)
  v_mfma_f32_32x32x16_bf16 v[204:219], v[16:19], v[116:119], v[204:219]
  v_add_u32 v1, s71, v252
  ds_read_b128 v[16:19], v1 offset:0
  s_waitcnt lgkmcnt(5)
  v_mfma_f32_32x32x16_bf16 v[204:219], v[20:23], v[120:123], v[204:219]
  ds_read_b128 v[20:23], v1 offset:32
  s_waitcnt lgkmcnt(5)
  v_mfma_f32_32x32x16_bf16 v[204:219], v[24:27], v[124:127], v[204:219]
  ds_read_b128 v[24:27], v1 offset:64
  s_waitcnt lgkmcnt(5)
  v_mfma_f32_32x32x16_bf16 v[204:219], v[28:31], v[128:131], v[204:219]
  ds_read_b128 v[28:31], v1 offset:96
  s_waitcnt lgkmcnt(5)
  v_mfma_f32_32x32x16_bf16 v[204:219], v[32:35], v[132:135], v[204:219]
  s_waitcnt lgkmcnt(4)
  v_mfma_f32_32x32x16_bf16 v[204:219], v[36:39], v[136:139], v[204:219]
  s_waitcnt lgkmcnt(3)
  v_mfma_f32_32x32x16_bf16 v[204:219], v[16:19], v[140:143], v[204:219]
  s_waitcnt lgkmcnt(2)
  v_mfma_f32_32x32x16_bf16 v[204:219], v[20:23], v[144:147], v[204:219]
  s_waitcnt lgkmcnt(1)
  v_mfma_f32_32x32x16_bf16 v[204:219], v[24:27], v[148:151], v[204:219]
  s_waitcnt lgkmcnt(0)
  v_mfma_f32_32x32x16_bf16 v[204:219], v[28:31], v[152:155], v[204:219]
  s_lshl_b32 s50, s44, 2
  s_and_b32 s51, s3, 3
  s_add_u32 s50, s50, s51
  s_lshl_b32 s50, s50, 7
  s_add_u32 s50, s50, 14155776
  v_and_b32 v2, 31, v0
  v_lshlrev_b32 v2, 2, v2
  s_nop 4
  v_mul_f32 v1, s63, v204
  v_exp_f32 v1, v1
  s_nop 0
  v_add_f32 v1, 1.0, v1
  v_rcp_f32 v1, v1
  s_mov_b32 exec_hi, 0
  buffer_store_dword v1, v2, s[24:27], s50 offen sc1
  s_mov_b32 exec_hi, -1
L_nogate_7:
L_ffn_join_4:
  s_waitcnt vmcnt(0)
  s_barrier
  s_lshl_b32 s51, s44, 7
  s_lshl_b32 s52, s45, 4
  s_add_u32 s51, s51, s52
  s_add_u32 s51, s51, 13893632
  s_cmp_lg_u32 s3, 0
  s_cbranch_scc1 L_nohf_8
  v_mov_b32 v2, s48
  v_mov_b32 v3, s48
  v_mov_b32 v4, 0
  s_mov_b64 exec, 1
  buffer_store_dwordx2 v[2:3], v4, s[24:27], s51 offen sc1
  s_mov_b64 exec, -1
L_nohf_8:
  s_branch L_phase2_ffn
L_att:
  s_mov_b32 s12, s66
  s_mov_b32 s13, s67
  s_mov_b32 s14, 1204224
  v_lshrrev_b32 v1, 3, v0
  v_and_b32 v2, 7, v0
  v_lshrrev_b32 v3, 1, v1
  v_and_b32 v3, 1, v3
  v_lshlrev_b32 v3, 2, v3
  v_xor_b32 v2, v2, v3
  v_min_u32 v2, 6, v2
  v_mul_u32_u24 v1, 2688, v1
  v_lshl_add_u32 v12, v2, 4, v1
  s_mul_i32 s50, s45, 112
  s_mul_i32 s51, s3, 21504
  s_add_u32 s58, s50, s51
  s_add_u32 s50, s44, s45
  s_and_b32 s50, s50, 3
  s_lshl_b32 s50, s50, 1
  s_add_u32 s50, s50, 1
  s_add_u32 s51, s50, 0
  s_cmp_ge_u32 s51, 7
  s_cselect_b32 s52, 7, 0
  s_sub_u32 s51, s51, s52
  s_lshl_b32 s65, s51, 7
  s_mul_i32 s90, s65, 1344
  s_add_u32 s51, s50, 1
  s_cmp_ge_u32 s51, 7
  s_cselect_b32 s52, 7, 0
  s_sub_u32 s51, s51, s52
  s_lshl_b32 s66, s51, 7
  s_mul_i32 s91, s66, 1344
  s_add_u32 s51, s50, 2
  s_cmp_ge_u32 s51, 7
  s_cselect_b32 s52, 7, 0
  s_sub_u32 s51, s51, s52
  s_lshl_b32 s67, s51, 7
  s_mul_i32 s92, s67, 1344
  s_add_u32 s51, s50, 3
  s_cmp_ge_u32 s51, 7
  s_cselect_b32 s52, 7, 0
  s_sub_u32 s51, s51, s52
  s_lshl_b32 s68, s51, 7
  s_mul_i32 s93, s68, 1344
  s_add_u32 s51, s50, 4
  s_cmp_ge_u32 s51, 7
  s_cselect_b32 s52, 7, 0
  s_sub_u32 s51, s51, s52
  s_lshl_b32 s69, s51, 7
  s_mul_i32 s94, s69, 1344
  s_add_u32 s51, s50, 5
  s_cmp_ge_u32 s51, 7
  s_cselect_b32 s52, 7, 0
  s_sub_u32 s51, s51, s52
  s_lshl_b32 s70, s51, 7
  s_mul_i32 s95, s70, 1344
  s_add_u32 s51, s50, 6
  s_cmp_ge_u32 s51, 7
  s_cselect_b32 s52, 7, 0
  s_sub_u32 s51, s51, s52
  s_lshl_b32 s71, s51, 7
  s_mul_i32 s96, s71, 1344
  v_add_u32 v10, s56, v10
  v_add_u32 v11, s56, v11
  v_add_u32 v9, s73, v12
  v_add_u32 v12, s58, v12
  s_add_u32 m0, s57, 0
  s_nop 0
  buffer_load_dwordx4 v10, s[8:11], s65 offen lds
  s_add_u32 m0, s57, 1024
  s_nop 0
  buffer_load_dwordx4 v11, s[8:11], s65 offen lds
  s_add_u32 m0, s59, 146560
  s_nop 0
  buffer_load_dwordx4 v12, s[12:15], s90 offen offset:896 lds
  v_lshlrev_b32 v1, 4, v0
  s_and_b32 s50, s3, 3
  s_lshl_b32 s50, s50, 10
  s_add_u32 m0, s50, 156672
  s_mul_i32 s51, s45, 3136
  s_add_u32 s50, s50, s51
  buffer_load_dwordx4 v1, s[36:39], s50 offen lds
  s_barrier
  s_add_u32 m0, s57, 16384
  s_nop 0
  buffer_load_dwordx4 v10, s[8:11], s66 offen lds
  s_add_u32 m0, s57, 17408
  s_nop 0
  buffer_load_dwordx4 v11, s[8:11], s66 offen lds
  s_add_u32 m0, s59, 138368
  s_nop 0
  buffer_load_dwordx4 v12, s[12:15], s91 offen offset:896 lds
  v_and_b32 v1, 31, v0
  v_lshrrev_b32 v2, 5, v0
  v_lshrrev_b32 v3, 1, v1
  v_and_b32 v3, 7, v3
  v_xor_b32 v2, v2, v3
  v_lshlrev_b32 v1, 7, v1
  s_and_b32 s50, s3, 3
  s_lshl_b32 s50, s50, 12
  v_add_u32 v1, s50, v1
  v_xor_b32 v3, 0, v2
  v_lshl_add_u32 v248, v3, 4, v1
  v_add_u32 v40, 0x10000, v248
  v_add_u32 v188, 0x20000, v248
  v_xor_b32 v3, 2, v2
  v_lshl_add_u32 v249, v3, 4, v1
  v_add_u32 v41, 0x10000, v249
  v_add_u32 v189, 0x20000, v249
  v_xor_b32 v3, 4, v2
  v_lshl_add_u32 v250, v3, 4, v1
  v_add_u32 v42, 0x10000, v250
  v_add_u32 v190, 0x20000, v250
  v_xor_b32 v3, 6, v2
  v_lshl_add_u32 v251, v3, 4, v1
  v_add_u32 v43, 0x10000, v251
  v_add_u32 v191, 0x20000, v251
  s_lshr_b32 s54, s3, 2
  s_mul_i32 s51, s54, 56
  v_bfe_u32 v1, v0, 4, 1
  v_lshlrev_b32 v1, 5, v1
  v_and_b32 v2, 3, v0
  v_lshl_add_u32 v1, v2, 3, v1
  v_add_u32 v1, s51, v1
  v_bfe_u32 v2, v0, 2, 2
  v_lshrrev_b32 v3, 1, v2
  v_lshlrev_b32 v3, 6, v3
  v_xor_b32 v1, v1, v3
  v_lshrrev_b32 v3, 5, v0
  v_lshl_add_u32 v3, v3, 3, v2
  v_lshl_add_u32 v13, v3, 7, v1
  v_add_u32 v14, 0x10000, v13
  v_add_u32 v15, 0x20000, v13
  v_lshrrev_b32 v1, 5, v0
  v_lshlrev_b32 v1, 4, v1
  v_add_u32 v252, 155648, v1
  v_mov_b32 v8, 0xff800000
  v_mov_b32 v9, 0x7f800000
  v_and_b32 v1, 31, v0
  v_lshrrev_b32 v2, 5, v0
  v_lshlrev_b32 v2, 2, v2
  v_sub_u32 v1, v1, v2
  v_mov_b32 v3, 0x3f80
  v_mov_b32 v4, 0x3f800000
  v_cmp_eq_u32 vcc, 0, v1
  s_nop 1
  v_cndmask_b32 v228, 0, v3, vcc
  v_cmp_eq_u32 vcc, 1, v1
  s_nop 1
  v_cndmask_b32 v228, v228, v4, vcc
  v_cmp_eq_u32 vcc, 2, v1
  s_nop 1
  v_cndmask_b32 v229, 0, v3, vcc
  v_cmp_eq_u32 vcc, 3, v1
  s_nop 1
  v_cndmask_b32 v229, v229, v4, vcc
  v_cmp_eq_u32 vcc, 8, v1
  s_nop 1
  v_cndmask_b32 v230, 0, v3, vcc
  v_cmp_eq_u32 vcc, 9, v1
  s_nop 1
  v_cndmask_b32 v230, v230, v4, vcc
  v_cmp_eq_u32 vcc, 10, v1
  s_nop 1
  v_cndmask_b32 v231, 0, v3, vcc
  v_cmp_eq_u32 vcc, 11, v1
  s_nop 1
  v_cndmask_b32 v231, v231, v4, vcc
  v_cmp_eq_u32 vcc, 16, v1
  s_nop 1
  v_cndmask_b32 v232, 0, v3, vcc
  v_cmp_eq_u32 vcc, 17, v1
  s_nop 1
  v_cndmask_b32 v232, v232, v4, vcc
  v_cmp_eq_u32 vcc, 18, v1
  s_nop 1
  v_cndmask_b32 v233, 0, v3, vcc
  v_cmp_eq_u32 vcc, 19, v1
  s_nop 1
  v_cndmask_b32 v233, v233, v4, vcc
  v_cmp_eq_u32 vcc, 24, v1
  s_nop 1
  v_cndmask_b32 v234, 0, v3, vcc
  v_cmp_eq_u32 vcc, 25, v1
  s_nop 1
  v_cndmask_b32 v234, v234, v4, vcc
  v_cmp_eq_u32 vcc, 26, v1
  s_nop 1
  v_cndmask_b32 v235, 0, v3, vcc
  v_cmp_eq_u32 vcc, 27, v1
  s_nop 1
  v_cndmask_b32 v235, v235, v4, vcc
  s_waitcnt vmcnt(3)
  s_barrier
  ds_read_b128 v[44:47], v248 offset:0
  ds_read_b64_tr_b16 v[16:17], v15 offset:16384
  ds_read_b64_tr_b16 v[18:19], v15 offset:16896
  ds_read_b128 v[48:51], v249 offset:0
  ds_read_b64_tr_b16 v[20:21], v15 offset:18432
  ds_read_b64_tr_b16 v[22:23], v15 offset:18944
  ds_read_b128 v[52:55], v250 offset:0
  ds_read_b64_tr_b16 v[24:25], v15 offset:20480
  ds_read_b64_tr_b16 v[26:27], v15 offset:20992
  s_waitcnt lgkmcnt(6)
  v_mfma_f32_32x32x16_bf16 v[156:171], v[16:19], v[44:47], 0
  ds_read_b128 v[56:59], v251 offset:0
  ds_read_b64_tr_b16 v[28:29], v15 offset:22528
  ds_read_b64_tr_b16 v[30:31], v15 offset:23040
  s_add_u32 m0, s57, 32768
  s_nop 0
  buffer_load_dwordx4 v10, s[8:11], s67 offen lds
  s_waitcnt vmcnt(1)
  s_barrier
  s_waitcnt lgkmcnt(6)
  v_mfma_f32_32x32x16_bf16 v[156:171], v[20:23], v[48:51], v[156:171]
  ds_read_b128 v[60:63], v248 offset:16384
  ds_read_b64_tr_b16 v[16:17], v15 offset:8192
  ds_read_b64_tr_b16 v[18:19], v15 offset:8704
  s_add_u32 m0, s57, 33792
  s_nop 0
  buffer_load_dwordx4 v11, s[8:11], s67 offen lds
  s_waitcnt lgkmcnt(6)
  v_mfma_f32_32x32x16_bf16 v[156:171], v[24:27], v[52:55], v[156:171]
  ds_read_b128 v[64:67], v249 offset:16384
  ds_read_b64_tr_b16 v[20:21], v15 offset:10240
  ds_read_b64_tr_b16 v[22:23], v15 offset:10752
  s_add_u32 m0, s59, 130176
  s_nop 0
  buffer_load_dwordx4 v12, s[12:15], s92 offen offset:896 lds
  s_waitcnt lgkmcnt(6)
  v_mfma_f32_32x32x16_bf16 v[156:171], v[28:31], v[56:59], v[156:171]
  ds_read_b128 v[68:71], v250 offset:16384
  ds_read_b64_tr_b16 v[24:25], v15 offset:12288
  ds_read_b64_tr_b16 v[26:27], v15 offset:12800
  s_add_u32 m0, s57, 49152
  s_nop 0
  buffer_load_dwordx4 v10, s[8:11], s68 offen lds
  s_waitcnt lgkmcnt(6)
  v_mfma_f32_32x32x16_bf16 v[156:171], v[16:19], v[60:63], v[156:171]
  ds_read_b128 v[72:75], v251 offset:16384
  ds_read_b64_tr_b16 v[28:29], v15 offset:14336
  ds_read_b64_tr_b16 v[30:31], v15 offset:14848
  s_add_u32 m0, s57, 50176
  s_nop 0
  buffer_load_dwordx4 v11, s[8:11], s68 offen lds
  s_waitcnt vmcnt(2)
  s_barrier
  s_waitcnt lgkmcnt(6)
  v_mfma_f32_32x32x16_bf16 v[156:171], v[20:23], v[64:67], v[156:171]
  ds_read_b128 v[76:79], v248 offset:32768
  ds_read_b64_tr_b16 v[16:17], v15 offset:0
  ds_read_b64_tr_b16 v[18:19], v15 offset:512
  s_add_u32 m0, s59, 121984
  s_nop 0
  buffer_load_dwordx4 v12, s[12:15], s93 offen offset:896 lds
  s_waitcnt lgkmcnt(6)
  v_mfma_f32_32x32x16_bf16 v[156:171], v[24:27], v[68:71], v[156:171]
  ds_read_b128 v[80:83], v249 offset:32768
  ds_read_b64_tr_b16 v[20:21], v15 offset:2048
  ds_read_b64_tr_b16 v[22:23], v15 offset:2560
  s_add_u32 m0, s57, 0
  s_nop 0
  buffer_load_dwordx4 v10, s[8:11], s69 offen lds
  s_waitcnt lgkmcnt(6)
  v_mfma_f32_32x32x16_bf16 v[156:171], v[28:31], v[72:75], v[156:171]
  ds_read_b128 v[84:87], v250 offset:32768
  ds_read_b64_tr_b16 v[24:25], v15 offset:4096
  ds_read_b64_tr_b16 v[26:27], v15 offset:4608
  s_add_u32 m0, s57, 1024
  s_nop 0
  buffer_load_dwordx4 v11, s[8:11], s69 offen lds
  s_waitcnt lgkmcnt(6)
  v_mfma_f32_32x32x16_bf16 v[156:171], v[16:19], v[76:79], v[156:171]
  ds_read_b128 v[88:91], v251 offset:32768
  ds_read_b64_tr_b16 v[28:29], v15 offset:6144
  ds_read_b64_tr_b16 v[30:31], v15 offset:6656
  s_add_u32 m0, s59, 113792
  s_nop 0
  buffer_load_dwordx4 v12, s[12:15], s94 offen offset:896 lds
  s_waitcnt vmcnt(3)
  s_barrier
  s_waitcnt lgkmcnt(6)
  v_mfma_f32_32x32x16_bf16 v[156:171], v[20:23], v[80:83], v[156:171]
  ds_read_b128 v[92:95], v248 offset:49152
  ds_read_b64_tr_b16 v[16:17], v14 offset:57344
  ds_read_b64_tr_b16 v[18:19], v14 offset:57856
  s_add_u32 m0, s57, 16384
  s_nop 0
  buffer_load_dwordx4 v10, s[8:11], s70 offen lds
  s_waitcnt lgkmcnt(6)
  v_mfma_f32_32x32x16_bf16 v[156:171], v[24:27], v[84:87], v[156:171]
  ds_read_b128 v[96:99], v249 offset:49152
  ds_read_b64_tr_b16 v[20:21], v14 offset:59392
  ds_read_b64_tr_b16 v[22:23], v14 offset:59904
  s_add_u32 m0, s57, 17408
  s_nop 0
  buffer_load_dwordx4 v11, s[8:11], s70 offen lds
  s_waitcnt lgkmcnt(6)
  v_mfma_f32_32x32x16_bf16 v[156:171], v[28:31], v[88:91], v[156:171]
  ds_read_b128 v[100:103], v250 offset:49152
  ds_read_b64_tr_b16 v[24:25], v14 offset:61440
  ds_read_b64_tr_b16 v[26:27], v14 offset:61952
  s_add_u32 m0, s59, 138368
  s_nop 0
  buffer_load_dwordx4 v12, s[12:15], s95 offen offset:896 lds
  s_waitcnt lgkmcnt(6)
  v_mfma_f32_32x32x16_bf16 v[156:171], v[16:19], v[92:95], v[156:171]
  ds_read_b128 v[104:107], v251 offset:49152
  ds_read_b64_tr_b16 v[28:29], v14 offset:63488
  ds_read_b64_tr_b16 v[30:31], v14 offset:64000
  s_waitcnt vmcnt(3)
  s_barrier
  s_waitcnt lgkmcnt(6)
  v_mfma_f32_32x32x16_bf16 v[156:171], v[20:23], v[96:99], v[156:171]
  ds_read_b128 v[108:111], v248 offset:0
  ds_read_b64_tr_b16 v[16:17], v14 offset:49152
  ds_read_b64_tr_b16 v[18:19], v14 offset:49664
  s_add_u32 m0, s57, 32768
  s_nop 0
  buffer_load_dwordx4 v10, s[8:11], s71 offen lds
  s_waitcnt lgkmcnt(6)
  v_mfma_f32_32x32x16_bf16 v[156:171], v[24:27], v[100:103], v[156:171]
  ds_read_b128 v[112:115], v249 offset:0
  ds_read_b64_tr_b16 v[20:21], v14 offset:51200
  ds_read_b64_tr_b16 v[22:23], v14 offset:51712
  s_add_u32 m0, s57, 33792
  s_nop 0
  buffer_load_dwordx4 v11, s[8:11], s71 offen lds
  s_waitcnt lgkmcnt(6)
  v_mfma_f32_32x32x16_bf16 v[156:171], v[28:31], v[104:107], v[156:171]
  ds_read_b128 v[116:119], v250 offset:0
  ds_read_b64_tr_b16 v[24:25], v14 offset:53248
  ds_read_b64_tr_b16 v[26:27], v14 offset:53760
  s_add_u32 m0, s59, 64640
  s_nop 0
  buffer_load_dwordx4 v12, s[12:15], s96 offen offset:896 lds
  s_waitcnt lgkmcnt(6)
  v_mfma_f32_32x32x16_bf16 v[156:171], v[16:19], v[108:111], v[156:171]
  ds_read_b128 v[120:123], v251 offset:0
  ds_read_b64_tr_b16 v[28:29], v14 offset:55296
  ds_read_b64_tr_b16 v[30:31], v14 offset:55808
  s_add_u32 m0, s59, 88320
  s_nop 0
  buffer_load_dwordx4 v12, s[12:15], s90 offen offset:1792 lds
  s_waitcnt vmcnt(4)
  s_barrier
  s_waitcnt lgkmcnt(6)
  v_mfma_f32_32x32x16_bf16 v[156:171], v[20:23], v[112:115], v[156:171]
  ds_read_b128 v[124:127], v248 offset:16384
  ds_read_b64_tr_b16 v[16:17], v15 offset:8192
  ds_read_b64_tr_b16 v[18:19], v15 offset:8704
  s_add_u32 m0, s59, 80128
  s_nop 0
  buffer_load_dwordx4 v12, s[12:15], s91 offen offset:1792 lds
  s_waitcnt lgkmcnt(6)
  v_mfma_f32_32x32x16_bf16 v[156:171], v[24:27], v[116:119], v[156:171]
  ds_read_b128 v[128:131], v249 offset:16384
  ds_read_b64_tr_b16 v[20:21], v15 offset:10240
  ds_read_b64_tr_b16 v[22:23], v15 offset:10752
  s_add_u32 m0, s59, 71936
  s_nop 0
  buffer_load_dwordx4 v12, s[12:15], s92 offen offset:1792 lds
  s_waitcnt lgkmcnt(6)
  v_mfma_f32_32x32x16_bf16 v[156:171], v[28:31], v[120:123], v[156:171]
  ds_read_b128 v[132:135], v250 offset:16384
  ds_read_b64_tr_b16 v[24:25], v15 offset:12288
  ds_read_b64_tr_b16 v[26:27], v15 offset:12800
  s_add_u32 m0, s59, 55552
  s_nop 0
  buffer_load_dwordx4 v12, s[12:15], s93 offen offset:1792 lds
  s_waitcnt lgkmcnt(6)
  v_mfma_f32_32x32x16_bf16 v[156:171], v[16:19], v[124:127], v[156:171]
  ds_read_b128 v[136:139], v251 offset:16384
  ds_read_b64_tr_b16 v[28:29], v15 offset:14336
  ds_read_b64_tr_b16 v[30:31], v15 offset:14848
  s_add_u32 m0, s59, 47360
  s_nop 0
  buffer_load_dwordx4 v12, s[12:15], s94 offen offset:1792 lds
  s_waitcnt vmcnt(5)
  s_barrier
  s_waitcnt lgkmcnt(6)
  v_mfma_f32_32x32x16_bf16 v[156:171], v[20:23], v[128:131], v[156:171]
  ds_read_b128 v[140:143], v248 offset:32768
  ds_read_b64_tr_b16 v[16:17], v14 offset:0
  ds_read_b64_tr_b16 v[18:19], v14 offset:512
  s_add_u32 m0, s59, 6400
  s_nop 0
  buffer_load_dwordx4 v12, s[12:15], s95 offen offset:1792 lds
  s_waitcnt lgkmcnt(6)
  v_mfma_f32_32x32x16_bf16 v[156:171], v[24:27], v[132:135], v[156:171]
  ds_read_b128 v[144:147], v249 offset:32768
  ds_read_b64_tr_b16 v[20:21], v14 offset:2048
  ds_read_b64_tr_b16 v[22:23], v14 offset:2560
  s_add_u32 m0, s59, 0
  s_add_u32 s50, s96, 1792
  buffer_load_dwordx4 v12, s[12:15], s50 offen lds
  s_waitcnt lgkmcnt(6)
  v_mfma_f32_32x32x16_bf16 v[156:171], v[28:31], v[136:139], v[156:171]
  ds_read_b128 v[148:151], v250 offset:32768
  ds_read_b64_tr_b16 v[24:25], v14 offset:4096
  ds_read_b64_tr_b16 v[26:27], v14 offset:4608
  s_add_u32 m0, s59, 147456
  s_nop 0
  buffer_load_dwordx4 v12, s[12:15], s90 offen lds
  s_waitcnt lgkmcnt(6)
  v_mfma_f32_32x32x16_bf16 v[156:171], v[16:19], v[140:143], v[156:171]
  ds_read_b128 v[152:155], v251 offset:32768
  ds_read_b64_tr_b16 v[28:29], v14 offset:6144
  ds_read_b64_tr_b16 v[30:31], v14 offset:6656
  s_add_u32 m0, s59, 131072
  s_nop 0
  buffer_load_dwordx4 v12, s[12:15], s91 offen lds
  s_waitcnt lgkmcnt(6)
  v_mfma_f32_32x32x16_bf16 v[156:171], v[20:23], v[144:147], v[156:171]
  s_waitcnt lgkmcnt(3)
  v_mfma_f32_32x32x16_bf16 v[156:171], v[24:27], v[148:151], v[156:171]
  s_waitcnt lgkmcnt(0)
  v_mfma_f32_32x32x16_bf16 v[156:171], v[28:31], v[152:155], v[156:171]
  v_mov_b32 v1, 0
  buffer_load_dword v43, v1, s[32:35], 0 offen sc1
  s_barrier
  v_lshlrev_b32 v244, 4, v0
  v_lshrrev_b32 v1, 3, v0
  v_and_b32 v2, 7, v0
  v_lshrrev_b32 v3, 1, v1
  v_and_b32 v3, 1, v3
  v_lshlrev_b32 v3, 2, v3
  v_xor_b32 v2, v2, v3
  v_mul_u32_u24 v1, 896, v1
  v_lshl_add_u32 v245, v2, 4, v1
  s_lshr_b32 s50, s3, 2
  s_lshl_b32 s51, s46, 1
  s_add_u32 s51, s51, s50
  s_mul_i32 s51, s51, 144
  s_and_b32 s52, s3, 3
  s_add_u32 s51, s51, s52
  s_lshl_b32 s84, s51, 10
  s_lshl_b32 s53, s47, 7
  s_mul_i32 s51, s3, 7168
  s_add_u32 s85, s51, s53
  s_mul_i32 s51, s50, 28
  s_lshl_b32 s52, s52, 3
  s_add_u32 s51, s51, s52
  s_mul_i32 s51, s51, 896
  s_add_u32 s86, s51, s53
  s_lshl_b32 s87, s3, 10
  s_and_b32 s51, s3, 1
  s_lshl_b32 s51, s51, 2
  s_lshl_b32 s52, s50, 1
  s_add_u32 s51, s51, s52
  s_lshl_b32 s51, s51, 10
  v_add_u32 v246, s51, v244
  v_lshrrev_b32 v1, 5, v0
  v_lshlrev_b32 v1, 2, v1
  v_bfe_u32 v2, v0, 2, 2
  v_add_u32 v1, v1, v2
  v_lshlrev_b32 v1, 7, v1
  v_bfe_u32 v3, v0, 4, 1
  v_lshlrev_b32 v3, 1, v3
  v_bfe_u32 v4, v0, 1, 1
  v_add_u32 v3, v3, v4
  v_lshrrev_b32 v2, 1, v2
  v_lshlrev_b32 v2, 2, v2
  s_lshr_b32 s51, s3, 1
  s_and_b32 s51, s51, 1
  s_lshl_b32 s51, s51, 2
  v_add_u32 v3, s51, v3
  v_xor_b32 v3, v3, v2
  v_lshl_add_u32 v1, v3, 4, v1
  v_and_b32 v4, 1, v0
  v_lshl_add_u32 v1, v4, 3, v1
  s_lshl_b32 s51, s50, 12
  v_add_u32 v247, s51, v1
  v_add_u32 v249, 0x10000, v247
  v_add_u32 v246, 98304, v246
  s_and_b32 s50, s46, 3
  s_lshl_b32 s51, s50, 2
  s_lshl_b32 s52, s47, 1
  s_add_u32 s51, s51, s52
  s_mul_i32 s50, s50, 3
  s_add_u32 s50, s50, s47
  s_add_u32 s50, s50, 8
  v_add_u32 v1, s51, v0
  v_and_b32 v1, 15, v1
  v_lshrrev_b32 v2, 2, v1
  v_mul_u32_u24 v2, 7, v2
  v_and_b32 v3, 3, v1
  v_add_u32 v2, v2, v3
  v_and_b32 v3, 2, v1
  v_add_u32 v2, v2, v3
  v_add_u32 v1, s50, v0
  v_subrev_u32 v1, 24, v1
  v_mul_u32_u24 v3, 43, v1
  v_lshrrev_b32 v3, 9, v3
  v_mul_u32_u24 v3, 12, v3
  v_sub_u32 v1, v1, v3
  v_mul_u32_u24 v3, 43, v1
  v_lshrrev_b32 v3, 7, v3
  v_mul_u32_u24 v4, 3, v3
  v_sub_u32 v4, v1, v4
  v_mul_u32_u24 v3, 7, v3
  v_add_u32 v3, v3, v4
  v_and_b32 v4, 2, v4
  v_add_u32 v3, v3, v4
  v_add_u32 v3, 2, v3
  v_cmp_gt_u32 vcc, 16, v0
  s_nop 1
  v_cndmask_b32 v2, v3, v2, vcc
  v_mul_u32_u24 v250, 57344, v2
  v_add_u32 v250, s85, v250
  v_lshlrev_b32 v251, 12, v2
  v_add_u32 v251, s84, v251
  s_lshr_b32 s54, s3, 2
  s_mul_i32 s51, s54, 1568
  s_add_u32 s51, s51, 156672
  v_lshrrev_b32 v1, 5, v0
  v_bfe_u32 v2, v0, 2, 2
  v_lshl_add_u32 v1, v1, 2, v2
  v_mul_u32_u24 v1, 56, v1
  v_bfe_u32 v2, v0, 4, 1
  v_lshl_add_u32 v1, v2, 5, v1
  v_and_b32 v2, 3, v0
  v_lshl_add_u32 v1, v2, 3, v1
  v_add_u32 v1, s51, v1
  ds_read_b64_tr_b16 v[220:221], v1
  ds_read_b64_tr_b16 v[222:223], v1 offset:448
  ds_read_b64_tr_b16 v[224:225], v1 offset:896
  ds_read_b64_tr_b16 v[226:227], v1 offset:1344
  v_cvt_pk_bf16_f32 v204, v156, v157
  v_cvt_pk_bf16_f32 v205, v158, v159
  v_cvt_pk_bf16_f32 v206, v160, v161
  v_cvt_pk_bf16_f32 v207, v162, v163
  v_cvt_pk_bf16_f32 v208, v164, v165
  v_cvt_pk_bf16_f32 v209, v166, v167
  v_cvt_pk_bf16_f32 v210, v168, v169
  v_cvt_pk_bf16_f32 v211, v170, v171
  s_waitcnt lgkmcnt(0)
  v_cndmask_b32 v220, v220, 0, s[82:83]
  v_cndmask_b32 v221, v221, 0, s[82:83]
  v_cndmask_b32 v222, v222, 0, s[82:83]
  v_cndmask_b32 v223, v223, 0, s[82:83]
  v_cndmask_b32 v224, v224, 0, s[82:83]
  v_cndmask_b32 v225, v225, 0, s[82:83]
  v_cndmask_b32 v226, v226, 0, s[82:83]
  v_cndmask_b32 v227, v227, 0, s[82:83]
  v_cndmask_b32 v226, v226, 0, s[60:61]
  v_cndmask_b32 v227, v227, 0, s[60:61]
  s_mul_i32 s50, s49, 392
  s_mul_i32 s51, s3, 49
  s_add_u32 s50, s50, s51
  s_lshl_b32 s6, s50, 7
  s_mul_i32 s50, s49, 98
  s_mul_i32 s51, s3, 13
  s_add_u32 s50, s50, s51
  s_lshl_b32 s7, s50, 7
  v_min_u32 v5, 12, v0
  v_lshlrev_b32 v5, 7, v5
  s_waitcnt vmcnt(7)
  s_barrier
  ds_read_b64_tr_b16 v[16:17], v14 offset:24576
  ds_read_b64_tr_b16 v[18:19], v14 offset:25088
  ds_read_b64_tr_b16 v[20:21], v14 offset:26624
  ds_read_b64_tr_b16 v[22:23], v14 offset:27136
  ds_read_b64_tr_b16 v[24:25], v14 offset:28672
  ds_read_b64_tr_b16 v[26:27], v14 offset:29184
  ds_read_b64_tr_b16 v[28:29], v14 offset:30720
  ds_read_b64_tr_b16 v[30:31], v14 offset:31232
  ds_read_b64_tr_b16 v[32:33], v14 offset:16384
  ds_read_b64_tr_b16 v[34:35], v14 offset:16896
  ds_read_b64_tr_b16 v[36:37], v14 offset:18432
  ds_read_b64_tr_b16 v[38:39], v14 offset:18944
  s_waitcnt lgkmcnt(10)
  v_mfma_f32_32x32x16_bf16 v[156:171], v[44:47], v[16:19], 0
  ds_read_b64_tr_b16 v[16:17], v14 offset:20480
  ds_read_b64_tr_b16 v[18:19], v14 offset:20992
  v_mfma_f32_32x32x16_bf16 v[172:187], v[220:223], v[204:207], 0
  v_mfma_f32_32x32x16_bf16 v[172:187], v[224:227], v[208:211], v[172:187]
  s_add_u32 m0, s59, 139264
  s_nop 0
  buffer_load_dwordx4 v12, s[12:15], s92 offen lds
  s_nop 8
  v_cndmask_b32 v200, v184, v8, s[60:61]
  v_cndmask_b32 v216, v184, v9, s[60:61]
  v_cndmask_b32 v201, v185, v8, s[60:61]
  v_cndmask_b32 v217, v185, v9, s[60:61]
  v_cndmask_b32 v202, v186, v8, s[60:61]
  s_waitcnt lgkmcnt(10)
  v_mfma_f32_32x32x16_bf16 v[156:171], v[48:51], v[20:23], v[156:171]
  ds_read_b64_tr_b16 v[20:21], v14 offset:22528
  ds_read_b64_tr_b16 v[22:23], v14 offset:23040
  s_add_u32 m0, s59, 122880
  s_nop 0
  buffer_load_dwordx4 v12, s[12:15], s93 offen lds
  v_cndmask_b32 v218, v186, v9, s[60:61]
  v_cndmask_b32 v203, v187, v8, s[60:61]
  v_cndmask_b32 v219, v187, v9, s[60:61]
  v_max3_f32 v236, v172, v173, v174
  v_min3_f32 v237, v172, v173, v174
  s_add_u32 m0, s59, 114688
  s_nop 0
  buffer_load_dwordx4 v12, s[12:15], s94 offen lds
  v_max3_f32 v238, v175, v176, v177
  s_waitcnt lgkmcnt(10)
  v_mfma_f32_32x32x16_bf16 v[156:171], v[52:55], v[24:27], v[156:171]
  ds_read_b64_tr_b16 v[24:25], v14 offset:8192
  ds_read_b64_tr_b16 v[26:27], v14 offset:8704
  v_min3_f32 v239, v175, v176, v177
  v_max3_f32 v236, v236, v178, v179
  v_min3_f32 v237, v237, v178, v179
  v_max3_f32 v238, v238, v180, v181
  s_add_u32 m0, s59, 106496
  s_nop 0
  buffer_load_dwordx4 v12, s[12:15], s95 offen lds
  v_min3_f32 v239, v239, v180, v181
  v_max3_f32 v236, v236, v182, v183
  v_min3_f32 v237, v237, v182, v183
  s_waitcnt lgkmcnt(10)
  v_mfma_f32_32x32x16_bf16 v[156:171], v[56:59], v[28:31], v[156:171]
  ds_read_b64_tr_b16 v[28:29], v14 offset:10240
  ds_read_b64_tr_b16 v[30:31], v14 offset:10752
  v_max3_f32 v238, v238, v200, v201
  v_min3_f32 v239, v239, v216, v217
  s_add_u32 m0, s59, 98304
  s_nop 0
  buffer_load_dwordx4 v12, s[12:15], s96 offen lds
  v_max3_f32 v236, v236, v202, v203
  v_min3_f32 v237, v237, v218, v219
  v_max_f32 v236, v236, v238
  v_min_f32 v237, v237, v239
  v_mov_b32 v238, v236
  s_waitcnt lgkmcnt(10)
  v_mfma_f32_32x32x16_bf16 v[156:171], v[60:63], v[32:35], v[156:171]
  ds_read_b64_tr_b16 v[32:33], v14 offset:12288
  ds_read_b64_tr_b16 v[34:35], v14 offset:12800
  v_mov_b32 v239, v237
  v_permlane32_swap_b32 v236, v238
  s_nop 0
  v_permlane32_swap_b32 v237, v239
  v_max_f32 v236, v236, v238
  v_min_f32 v237, v237, v239
  v_mul_f32 v236, s62, v236
  v_mul_f32 v237, s62, v237
  v_fma_f32 v188, v172, s62, -v236
  s_waitcnt lgkmcnt(10)
  v_mfma_f32_32x32x16_bf16 v[156:171], v[64:67], v[36:39], v[156:171]
  ds_read_b64_tr_b16 v[36:37], v14 offset:14336
  ds_read_b64_tr_b16 v[38:39], v14 offset:14848
  v_fma_f32 v204, v172, s63, v237
  v_fma_f32 v189, v173, s62, -v236
  v_fma_f32 v205, v173, s63, v237
  v_fma_f32 v190, v174, s62, -v236
  v_fma_f32 v206, v174, s63, v237
  v_fma_f32 v191, v175, s62, -v236
  v_fma_f32 v207, v175, s63, v237
  v_fma_f32 v192, v176, s62, -v236
  s_waitcnt lgkmcnt(10)
  v_mfma_f32_32x32x16_bf16 v[156:171], v[68:71], v[16:19], v[156:171]
  s_waitcnt vmcnt(10)
  s_barrier
  ds_read_b64_tr_b16 v[16:17], v13 offset:57344
  ds_read_b64_tr_b16 v[18:19], v13 offset:57856
  v_fma_f32 v208, v176, s63, v237
  v_fma_f32 v193, v177, s62, -v236
  s_add_u32 s51, s6, 0
  s_mov_b64 exec, 0x1fff
  buffer_load_dword v7, v5, s[16:19], s51 offen
  s_mov_b64 exec, -1
  v_fma_f32 v209, v177, s63, v237
  v_fma_f32 v194, v178, s62, -v236
  v_fma_f32 v210, v178, s63, v237
  v_fma_f32 v195, v179, s62, -v236
  v_fma_f32 v211, v179, s63, v237
  s_waitcnt lgkmcnt(10)
  v_mfma_f32_32x32x16_bf16 v[156:171], v[72:75], v[20:23], v[156:171]
  ds_read_b64_tr_b16 v[20:21], v13 offset:59392
  ds_read_b64_tr_b16 v[22:23], v13 offset:59904
  v_fma_f32 v196, v180, s62, -v236
  v_fma_f32 v212, v180, s63, v237
  v_fma_f32 v197, v181, s62, -v236
  v_fma_f32 v213, v181, s63, v237
  v_fma_f32 v198, v182, s62, -v236
  v_fma_f32 v214, v182, s63, v237
  v_fma_f32 v199, v183, s62, -v236
  v_fma_f32 v215, v183, s63, v237
  s_waitcnt lgkmcnt(10)
  v_mfma_f32_32x32x16_bf16 v[156:171], v[76:79], v[24:27], v[156:171]
  ds_read_b64_tr_b16 v[24:25], v13 offset:61440
  ds_read_b64_tr_b16 v[26:27], v13 offset:61952
  v_fma_f32 v200, v200, s62, -v236
  v_fma_f32 v216, v216, s63, v237
  v_fma_f32 v201, v201, s62, -v236
  v_fma_f32 v217, v217, s63, v237
  v_fma_f32 v202, v202, s62, -v236
  v_fma_f32 v218, v218, s63, v237
  v_fma_f32 v203, v203, s62, -v236
  v_fma_f32 v219, v219, s63, v237
  s_waitcnt lgkmcnt(10)
  v_mfma_f32_32x32x16_bf16 v[156:171], v[80:83], v[28:31], v[156:171]
  ds_read_b64_tr_b16 v[28:29], v13 offset:63488
  ds_read_b64_tr_b16 v[30:31], v13 offset:64000
  v_exp_f32 v188, v188
  v_exp_f32 v204, v204
  v_exp_f32 v189, v189
  v_exp_f32 v205, v205
  v_exp_f32 v190, v190
  v_exp_f32 v206, v206
  v_exp_f32 v191, v191
  v_exp_f32 v207, v207
  s_waitcnt lgkmcnt(10)
  v_mfma_f32_32x32x16_bf16 v[156:171], v[84:87], v[32:35], v[156:171]
  ds_read_b64_tr_b16 v[32:33], v13 offset:49152
  ds_read_b64_tr_b16 v[34:35], v13 offset:49664
  s_add_u32 s51, s6, 1664
  s_mov_b64 exec, 0x1fff
  buffer_load_dword v7, v5, s[16:19], s51 offen
  s_mov_b64 exec, -1
  v_exp_f32 v192, v192
  v_exp_f32 v208, v208
  v_exp_f32 v193, v193
  v_exp_f32 v209, v209
  v_exp_f32 v194, v194
  v_exp_f32 v210, v210
  v_exp_f32 v195, v195
  s_waitcnt lgkmcnt(10)
  v_mfma_f32_32x32x16_bf16 v[156:171], v[88:91], v[36:39], v[156:171]
  ds_read_b64_tr_b16 v[36:37], v13 offset:51200
  ds_read_b64_tr_b16 v[38:39], v13 offset:51712
  v_exp_f32 v211, v211
  v_exp_f32 v196, v196
  v_exp_f32 v212, v212
  v_exp_f32 v197, v197
  v_exp_f32 v213, v213
  v_exp_f32 v198, v198
  v_exp_f32 v214, v214
  v_exp_f32 v199, v199
  s_waitcnt lgkmcnt(10)
  v_mfma_f32_32x32x16_bf16 v[156:171], v[92:95], v[16:19], v[156:171]
  ds_read_b64_tr_b16 v[16:17], v13 offset:53248
  ds_read_b64_tr_b16 v[18:19], v13 offset:53760
  v_exp_f32 v215, v215
  v_exp_f32 v200, v200
  v_exp_f32 v216, v216
  v_exp_f32 v201, v201
  v_exp_f32 v217, v217
  v_exp_f32 v202, v202
  v_exp_f32 v218, v218
  v_exp_f32 v203, v203
  s_waitcnt lgkmcnt(10)
  v_mfma_f32_32x32x16_bf16 v[156:171], v[96:99], v[20:23], v[156:171]
  ds_read_b64_tr_b16 v[20:21], v13 offset:55296
  ds_read_b64_tr_b16 v[22:23], v13 offset:55808
  v_exp_f32 v219, v219
  v_add_f32 v236, v188, v189
  v_add_f32 v237, v204, v205
  v_add_f32 v238, v190, v191
  v_add_f32 v239, v206, v207
  v_add_f32 v236, v236, v192
  s_add_u32 s51, s6, 3328
  s_mov_b64 exec, 0x1fff
  buffer_load_dword v7, v5, s[16:19], s51 offen
  s_mov_b64 exec, -1
  v_add_f32 v237, v237, v208
  s_waitcnt lgkmcnt(10)
  v_mfma_f32_32x32x16_bf16 v[156:171], v[100:103], v[24:27], v[156:171]
  s_waitcnt vmcnt(3)
  s_barrier
  ds_read_b64_tr_b16 v[24:25], v13 offset:8192
  ds_read_b64_tr_b16 v[26:27], v13 offset:8704
  v_add_f32 v238, v238, v193
  v_add_f32 v239, v239, v209
  v_add_f32 v236, v236, v194
  v_add_f32 v237, v237, v210
  v_add_f32 v238, v238, v195
  v_add_f32 v239, v239, v211
  v_add_f32 v236, v236, v196
  v_add_f32 v237, v237, v212
  s_waitcnt lgkmcnt(10)
  v_mfma_f32_32x32x16_bf16 v[156:171], v[104:107], v[28:31], v[156:171]
  ds_read_b64_tr_b16 v[28:29], v13 offset:10240
  ds_read_b64_tr_b16 v[30:31], v13 offset:10752
  v_add_f32 v238, v238, v197
  v_add_f32 v239, v239, v213
  v_add_f32 v236, v236, v198
  v_add_f32 v237, v237, v214
  v_add_f32 v238, v238, v199
  v_add_f32 v239, v239, v215
  v_add_f32 v236, v236, v200
  v_add_f32 v237, v237, v216
  s_waitcnt lgkmcnt(10)
  v_mfma_f32_32x32x16_bf16 v[156:171], v[108:111], v[32:35], v[156:171]
  ds_read_b64_tr_b16 v[32:33], v13 offset:12288
  ds_read_b64_tr_b16 v[34:35], v13 offset:12800
  v_add_f32 v238, v238, v201
  v_add_f32 v239, v239, v217
  v_add_f32 v236, v236, v202
  v_add_f32 v237, v237, v218
  v_add_f32 v238, v238, v203
  v_add_f32 v239, v239, v219
  v_add_f32 v236, v236, v238
  v_add_f32 v237, v237, v239
  s_waitcnt lgkmcnt(10)
  v_mfma_f32_32x32x16_bf16 v[156:171], v[112:115], v[36:39], v[156:171]
  ds_read_b64_tr_b16 v[36:37], v13 offset:14336
  ds_read_b64_tr_b16 v[38:39], v13 offset:14848
  v_mov_b32 v238, v236
  v_mov_b32 v239, v237
  s_nop 0
  v_permlane32_swap_b32 v236, v238
  v_permlane32_swap_b32 v237, v239
  s_add_u32 s51, s6, 4992
  s_mov_b64 exec, 0x1fff
  buffer_load_dword v7, v5, s[16:19], s51 offen
  s_mov_b64 exec, -1
  v_add_f32 v236, v236, v238
  v_add_f32 v237, v237, v239
  v_rcp_f32 v236, v236
  s_waitcnt lgkmcnt(10)
  v_mfma_f32_32x32x16_bf16 v[156:171], v[116:119], v[16:19], v[156:171]
  ds_read_b64_tr_b16 v[16:17], v13 offset:0
  ds_read_b64_tr_b16 v[18:19], v13 offset:512
  v_rcp_f32 v237, v237
  v_mul_f32 v188, v188, v236
  v_mul_f32 v204, v204, v237
  v_mul_f32 v189, v189, v236
  v_mul_f32 v205, v205, v237
  v_mul_f32 v190, v190, v236
  v_mul_f32 v206, v206, v237
  v_mul_f32 v191, v191, v236
  s_waitcnt lgkmcnt(10)
  v_mfma_f32_32x32x16_bf16 v[156:171], v[120:123], v[20:23], v[156:171]
  ds_read_b64_tr_b16 v[20:21], v13 offset:2048
  ds_read_b64_tr_b16 v[22:23], v13 offset:2560
  v_mul_f32 v207, v207, v237
  v_mul_f32 v192, v192, v236
  v_mul_f32 v208, v208, v237
  v_mul_f32 v193, v193, v236
  v_mul_f32 v209, v209, v237
  v_mul_f32 v194, v194, v236
  v_mul_f32 v210, v210, v237
  v_mul_f32 v195, v195, v236
  s_waitcnt lgkmcnt(10)
  v_mfma_f32_32x32x16_bf16 v[156:171], v[124:127], v[24:27], v[156:171]
  ds_read_b64_tr_b16 v[24:25], v13 offset:4096
  ds_read_b64_tr_b16 v[26:27], v13 offset:4608
  v_mul_f32 v211, v211, v237
  v_mul_f32 v196, v196, v236
  v_mul_f32 v212, v212, v237
  v_mul_f32 v197, v197, v236
  v_mul_f32 v213, v213, v237
  v_mul_f32 v198, v198, v236
  v_mul_f32 v214, v214, v237
  v_mul_f32 v199, v199, v236
  s_waitcnt lgkmcnt(10)
  v_mfma_f32_32x32x16_bf16 v[156:171], v[128:131], v[28:31], v[156:171]
  ds_read_b64_tr_b16 v[28:29], v13 offset:6144
  ds_read_b64_tr_b16 v[30:31], v13 offset:6656
  v_mul_f32 v215, v215, v237
  v_mul_f32 v200, v200, v236
  s_mov_b64 exec, 0x1fff
  buffer_load_dword v7, v5, s[20:23], s7 offen
  s_mov_b64 exec, -1
  v_mul_f32 v216, v216, v237
  v_mul_f32 v201, v201, v236
  v_mul_f32 v217, v217, v237
  v_mul_f32 v202, v202, v236
  v_mul_f32 v218, v218, v237
  s_waitcnt lgkmcnt(10)
  v_mfma_f32_32x32x16_bf16 v[156:171], v[132:135], v[32:35], v[156:171]
  v_mul_f32 v203, v203, v236
  v_mul_f32 v219, v219, v237
  v_cvt_pk_bf16_f32 v172, v188, v189
  v_cvt_pk_bf16_f32 v180, v204, v205
  v_cvt_pk_bf16_f32 v173, v190, v191
  v_cvt_pk_bf16_f32 v181, v206, v207
  v_cvt_pk_bf16_f32 v174, v192, v193
  v_cvt_pk_bf16_f32 v182, v208, v209
  s_waitcnt lgkmcnt(8)
  v_mfma_f32_32x32x16_bf16 v[156:171], v[136:139], v[36:39], v[156:171]
  v_cvt_pk_bf16_f32 v175, v194, v195
  v_cvt_pk_bf16_f32 v183, v210, v211
  v_cvt_pk_bf16_f32 v176, v196, v197
  v_cvt_pk_bf16_f32 v184, v212, v213
  v_cvt_pk_bf16_f32 v177, v198, v199
  v_cvt_pk_bf16_f32 v185, v214, v215
  v_cvt_pk_bf16_f32 v178, v200, v201
  v_cvt_pk_bf16_f32 v186, v216, v217
  s_waitcnt lgkmcnt(6)
  v_mfma_f32_32x32x16_bf16 v[156:171], v[140:143], v[16:19], v[156:171]
  v_cvt_pk_bf16_f32 v179, v202, v203
  v_cvt_pk_bf16_f32 v187, v218, v219
  v_mfma_f32_32x32x16_bf16 v[188:203], v[172:175], v[228:231], 0
  v_mfma_f32_32x32x16_bf16 v[188:203], v[176:179], v[232:235], v[188:203]
  v_mfma_f32_32x32x16_bf16 v[204:219], v[180:183], v[228:231], 0
  v_mfma_f32_32x32x16_bf16 v[204:219], v[184:187], v[232:235], v[204:219]
  s_nop 9
  v_cvt_pk_bf16_f32 v172, v188, v189
  v_cvt_pk_bf16_f32 v173, v190, v191
  s_waitcnt lgkmcnt(4)
  v_mfma_f32_32x32x16_bf16 v[156:171], v[144:147], v[20:23], v[156:171]
  v_cvt_pk_bf16_f32 v174, v192, v193
  v_cvt_pk_bf16_f32 v175, v194, v195
  v_cvt_pk_bf16_f32 v176, v196, v197
  v_cvt_pk_bf16_f32 v177, v198, v199
  v_cvt_pk_bf16_f32 v178, v200, v201
  v_cvt_pk_bf16_f32 v179, v202, v203
  v_cvt_pk_bf16_f32 v180, v204, v205
  v_cvt_pk_bf16_f32 v181, v206, v207
  s_waitcnt lgkmcnt(2)
  v_mfma_f32_32x32x16_bf16 v[156:171], v[148:151], v[24:27], v[156:171]
  v_cvt_pk_bf16_f32 v182, v208, v209
  v_cvt_pk_bf16_f32 v183, v210, v211
  v_cvt_pk_bf16_f32 v184, v212, v213
  v_cvt_pk_bf16_f32 v185, v214, v215
  v_cvt_pk_bf16_f32 v186, v216, v217
  v_cvt_pk_bf16_f32 v187, v218, v219
  s_waitcnt lgkmcnt(0)
  v_mfma_f32_32x32x16_bf16 v[156:171], v[152:155], v[28:31], v[156:171]
  s_nop 11
  v_cvt_pk_bf16_f32 v16, v156, v157
  v_cvt_pk_bf16_f32 v17, v158, v159
  v_cvt_pk_bf16_f32 v18, v160, v161
  v_cvt_pk_bf16_f32 v19, v162, v163
  v_cvt_pk_bf16_f32 v20, v164, v165
  v_cvt_pk_bf16_f32 v21, v166, v167
  v_cvt_pk_bf16_f32 v22, v168, v169
  v_cvt_pk_bf16_f32 v23, v170, v171
  v_readfirstlane_b32 s48, v43
  s_nop 0
  s_cmp_lg_u32 s48, 0
  s_nop 1
  s_cbranch_scc1 L_nd_10
  s_mov_b32 s88, 0x40000
  v_mov_b32 v1, 0
L_nq_9:
  buffer_load_dword v43, v1, s[32:35], 0 offen sc1
  s_waitcnt vmcnt(0)
  v_readfirstlane_b32 s48, v43
  s_sub_u32 s88, s88, 1
  s_cmp_eq_u32 s88, 0
  s_nop 1
  s_cbranch_scc1 L_nd_10
  s_cmp_eq_u32 s48, 0
  s_cbranch_scc1 L_nq_9
L_nd_10:
  s_mov_b32 s78, 0xff
  s_sub_u32 s79, 0, s48
  s_mov_b32 s4, 0x0c0c0400
  s_mov_b32 s5, 0x04000c0c
  v_mov_b32 v240, s48
  v_lshrrev_b32 v241, 8, v240
  v_lshrrev_b32 v242, 16, v240
  v_lshrrev_b32 v243, 24, v240
  v_mov_b32 v1, 0x3f803f80
  v_cndmask_b32 v16, v16, v1, s[80:81]
  v_cndmask_b32 v17, v17, v1, s[80:81]
  v_cndmask_b32 v18, v18, v1, s[80:81]
  v_cndmask_b32 v19, v19, v1, s[80:81]
  v_cndmask_b32 v20, v20, v1, s[80:81]
  v_cndmask_b32 v21, v21, v1, s[80:81]
  v_cndmask_b32 v22, v22, v1, s[80:81]
  v_cndmask_b32 v23, v23, v1, s[80:81]
  v_mfma_f32_32x32x16_bf16 v[188:203], v[172:175], v[16:19], 0
  s_nop 0
  v_mfma_f32_32x32x16_bf16 v[188:203], v[176:179], v[20:23], v[188:203]
  v_mfma_f32_32x32x16_bf16 v[204:219], v[180:183], v[16:19], 0
  v_mfma_f32_32x32x16_bf16 v[204:219], v[184:187], v[20:23], v[204:219]
  s_barrier
  s_lshl_b32 s50, s3, 13
  v_lshlrev_b32 v1, 4, v0
  v_add_u32 v2, s50, v1
  s_nop 5
  ds_write_b128 v2, v[188:191] offset:0
  ds_write_b128 v2, v[192:195] offset:1024
  ds_write_b128 v2, v[196:199] offset:2048
  ds_write_b128 v2, v[200:203] offset:3072
  ds_write_b128 v2, v[204:207] offset:4096
  ds_write_b128 v2, v[208:211] offset:5120
  ds_write_b128 v2, v[212:215] offset:6144
  ds_write_b128 v2, v[216:219] offset:7168
  s_and_b32 s50, s3, 4
  s_lshl_b32 s50, s50, 13
  s_and_b32 s51, s3, 3
  s_lshl_b32 s51, s51, 11
  s_add_u32 s50, s50, s51
  v_add_u32 v2, s50, v1
  s_waitcnt lgkmcnt(0)
  s_barrier
  ds_read_b128 v[188:191], v2 offset:0
  ds_read_b128 v[192:195], v2 offset:1024
  ds_read_b128 v[196:199], v2 offset:8192
  ds_read_b128 v[200:203], v2 offset:9216
  ds_read_b128 v[204:207], v2 offset:16384
  ds_read_b128 v[208:211], v2 offset:17408
  ds_read_b128 v[212:215], v2 offset:24576
  ds_read_b128 v[216:219], v2 offset:25600
  s_lshl_b32 s50, s45, 18
  s_lshl_b32 s51, s44, 14
  s_add_u32 s50, s50, s51
  s_lshl_b32 s51, s3, 11
  s_add_u32 s50, s50, s51
  s_add_u32 s50, s50, 10485760
  s_waitcnt lgkmcnt(0)
  v_add_f32 v188, v188, v196
  v_add_f32 v204, v204, v212
  v_add_f32 v189, v189, v197
  v_add_f32 v205, v205, v213
  v_add_f32 v190, v190, v198
  v_add_f32 v206, v206, v214
  v_add_f32 v191, v191, v199
  v_add_f32 v207, v207, v215
  v_add_f32 v192, v192, v200
  v_add_f32 v208, v208, v216
  v_add_f32 v193, v193, v201
  v_add_f32 v209, v209, v217
  v_add_f32 v194, v194, v202
  v_add_f32 v210, v210, v218
  v_add_f32 v195, v195, v203
  v_add_f32 v211, v211, v219
  v_add_f32 v188, v188, v204
  v_add_f32 v189, v189, v205
  v_add_f32 v190, v190, v206
  v_add_f32 v191, v191, v207
  v_add_f32 v192, v192, v208
  v_add_f32 v193, v193, v209
  v_add_f32 v194, v194, v210
  v_add_f32 v195, v195, v211
  v_bfi_b32 v188, s78, v240, v188
  v_bfi_b32 v189, s78, v241, v189
  v_bfi_b32 v190, s78, v242, v190
  v_bfi_b32 v191, s78, v243, v191
  v_bfi_b32 v192, s78, v240, v192
  v_bfi_b32 v193, s78, v241, v193
  v_bfi_b32 v194, s78, v242, v194
  v_bfi_b32 v195, s78, v243, v195
  buffer_store_dwordx4 v[188:191], v1, s[24:27], s50 offen sc1
  buffer_store_dwordx4 v[192:195], v1, s[24:27], s50 offen offset:1024 sc1
  s_cmp_lt_u32 s89, 28
  s_cbranch_scc1 L_att_sm_11
  s_cmp_ge_u32 s3, 4
  s_cbranch_scc1 L_att_sm_11
  s_cmp_lt_u32 s3, 4
  s_cbranch_scc1 L_nosleep_12
  s_sleep 16
L_nosleep_12:
  s_and_b32 s50, s2, 7
  s_lshl_b32 s50, s50, 2
  s_add_u32 s50, s50, s49
  s_sub_u32 s50, s50, 12
  s_lshl_b32 s50, s50, 2
  s_and_b32 s51, s3, 3
  s_add_u32 s50, s50, s51
  s_lshr_b32 s54, s50, 4
  s_and_b32 s55, s50, 15
  s_lshr_b32 s51, s55, 1
  s_lshl_b32 s51, s51, 11
  s_and_b32 s52, s55, 1
  s_lshl_b32 s52, s52, 9
  s_add_u32 s55, s51, s52
  v_lshrrev_b32 v1, 5, v0
  v_lshlrev_b32 v1, 10, v1
  v_and_b32 v2, 31, v0
  v_lshl_add_u32 v1, v2, 4, v1
  v_add_u32 v1, s55, v1
  s_lshl_b32 s50, s54, 18
  s_add_u32 s50, s50, 10485760
  s_mov_b32 s88, 0x40000
L_r1_13:
  s_add_u32 s51, s50, 0
  buffer_load_dwordx4 v[156:159], v1, s[24:27], s51 offen sc1
  s_add_u32 s51, s50, 16384
  buffer_load_dwordx4 v[160:163], v1, s[24:27], s51 offen sc1
  s_add_u32 s51, s50, 32768
  buffer_load_dwordx4 v[164:167], v1, s[24:27], s51 offen sc1
  s_add_u32 s51, s50, 49152
  buffer_load_dwordx4 v[168:171], v1, s[24:27], s51 offen sc1
  s_add_u32 s51, s50, 65536
  buffer_load_dwordx4 v[172:175], v1, s[24:27], s51 offen sc1
  s_add_u32 s51, s50, 81920
  buffer_load_dwordx4 v[176:179], v1, s[24:27], s51 offen sc1
  s_add_u32 s51, s50, 98304
  buffer_load_dwordx4 v[180:183], v1, s[24:27], s51 offen sc1
  s_add_u32 s51, s50, 114688
  buffer_load_dwordx4 v[184:187], v1, s[24:27], s51 offen sc1
  s_add_u32 s51, s50, 131072
  buffer_load_dwordx4 v[188:191], v1, s[24:27], s51 offen sc1
  s_add_u32 s51, s50, 147456
  buffer_load_dwordx4 v[192:195], v1, s[24:27], s51 offen sc1
  s_add_u32 s51, s50, 163840
  buffer_load_dwordx4 v[196:199], v1, s[24:27], s51 offen sc1
  s_add_u32 s51, s50, 180224
  buffer_load_dwordx4 v[200:203], v1, s[24:27], s51 offen sc1
  s_add_u32 s51, s50, 196608
  buffer_load_dwordx4 v[204:207], v1, s[24:27], s51 offen sc1
  s_add_u32 s51, s50, 212992
  buffer_load_dwordx4 v[208:211], v1, s[24:27], s51 offen sc1
  s_add_u32 s51, s50, 229376
  buffer_load_dwordx4 v[212:215], v1, s[24:27], s51 offen sc1
  s_add_u32 s51, s50, 245760
  buffer_load_dwordx4 v[216:219], v1, s[24:27], s51 offen sc1
  s_waitcnt vmcnt(0)
  v_mov_b32 v2, 0
  v_perm_b32 v3, v157, v156, s4
  v_perm_b32 v4, v159, v158, s5
  v_add3_u32 v3, v3, v4, s79
  v_or_b32 v2, v2, v3
  v_perm_b32 v3, v161, v160, s4
  v_perm_b32 v4, v163, v162, s5
  v_add3_u32 v3, v3, v4, s79
  v_or_b32 v2, v2, v3
  v_perm_b32 v3, v165, v164, s4
  v_perm_b32 v4, v167, v166, s5
  v_add3_u32 v3, v3, v4, s79
  v_or_b32 v2, v2, v3
  v_perm_b32 v3, v169, v168, s4
  v_perm_b32 v4, v171, v170, s5
  v_add3_u32 v3, v3, v4, s79
  v_or_b32 v2, v2, v3
  v_perm_b32 v3, v173, v172, s4
  v_perm_b32 v4, v175, v174, s5
  v_add3_u32 v3, v3, v4, s79
  v_or_b32 v2, v2, v3
  v_perm_b32 v3, v177, v176, s4
  v_perm_b32 v4, v179, v178, s5
  v_add3_u32 v3, v3, v4, s79
  v_or_b32 v2, v2, v3
  v_perm_b32 v3, v181, v180, s4
  v_perm_b32 v4, v183, v182, s5
  v_add3_u32 v3, v3, v4, s79
  v_or_b32 v2, v2, v3
  v_perm_b32 v3, v185, v184, s4
  v_perm_b32 v4, v187, v186, s5
  v_add3_u32 v3, v3, v4, s79
  v_or_b32 v2, v2, v3
  v_perm_b32 v3, v189, v188, s4
  v_perm_b32 v4, v191, v190, s5
  v_add3_u32 v3, v3, v4, s79
  v_or_b32 v2, v2, v3
  v_perm_b32 v3, v193, v192, s4
  v_perm_b32 v4, v195, v194, s5
  v_add3_u32 v3, v3, v4, s79
  v_or_b32 v2, v2, v3
  v_perm_b32 v3, v197, v196, s4
  v_perm_b32 v4, v199, v198, s5
  v_add3_u32 v3, v3, v4, s79
  v_or_b32 v2, v2, v3
  v_perm_b32 v3, v201, v200, s4
  v_perm_b32 v4, v203, v202, s5
  v_add3_u32 v3, v3, v4, s79
  v_or_b32 v2, v2, v3
  v_perm_b32 v3, v205, v204, s4
  v_perm_b32 v4, v207, v206, s5
  v_add3_u32 v3, v3, v4, s79
  v_or_b32 v2, v2, v3
  v_perm_b32 v3, v209, v208, s4
  v_perm_b32 v4, v211, v210, s5
  v_add3_u32 v3, v3, v4, s79
  v_or_b32 v2, v2, v3
  v_perm_b32 v3, v213, v212, s4
  v_perm_b32 v4, v215, v214, s5
  v_add3_u32 v3, v3, v4, s79
  v_or_b32 v2, v2, v3
  v_perm_b32 v3, v217, v216, s4
  v_perm_b32 v4, v219, v218, s5
  v_add3_u32 v3, v3, v4, s79
  v_or_b32 v2, v2, v3
  v_cmp_ne_u32 vcc, 0, v2
  s_nop 0
  s_cmp_eq_u64 vcc, 0
  s_nop 1
  s_cbranch_scc1 L_r1ok_14
  s_sub_u32 s88, s88, 1
  s_cmp_eq_u32 s88, 0
  s_cbranch_scc0 L_r1_13
L_r1ok_14:
  v_add_f32 v156, v156, v188
  v_add_f32 v157, v157, v189
  v_add_f32 v158, v158, v190
  v_add_f32 v159, v159, v191
  v_add_f32 v160, v160, v192
  v_add_f32 v161, v161, v193
  v_add_f32 v162, v162, v194
  v_add_f32 v163, v163, v195
  v_add_f32 v164, v164, v196
  v_add_f32 v165, v165, v197
  v_add_f32 v166, v166, v198
  v_add_f32 v167, v167, v199
  v_add_f32 v168, v168, v200
  v_add_f32 v169, v169, v201
  v_add_f32 v170, v170, v202
  v_add_f32 v171, v171, v203
  v_add_f32 v172, v172, v204
  v_add_f32 v173, v173, v205
  v_add_f32 v174, v174, v206
  v_add_f32 v175, v175, v207
  v_add_f32 v176, v176, v208
  v_add_f32 v177, v177, v209
  v_add_f32 v178, v178, v210
  v_add_f32 v179, v179, v211
  v_add_f32 v180, v180, v212
  v_add_f32 v181, v181, v213
  v_add_f32 v182, v182, v214
  v_add_f32 v183, v183, v215
  v_add_f32 v184, v184, v216
  v_add_f32 v185, v185, v217
  v_add_f32 v186, v186, v218
  v_add_f32 v187, v187, v219
  v_add_f32 v156, v156, v172
  v_add_f32 v157, v157, v173
  v_add_f32 v158, v158, v174
  v_add_f32 v159, v159, v175
  v_add_f32 v160, v160, v176
  v_add_f32 v161, v161, v177
  v_add_f32 v162, v162, v178
  v_add_f32 v163, v163, v179
  v_add_f32 v164, v164, v180
  v_add_f32 v165, v165, v181
  v_add_f32 v166, v166, v182
  v_add_f32 v167, v167, v183
  v_add_f32 v168, v168, v184
  v_add_f32 v169, v169, v185
  v_add_f32 v170, v170, v186
  v_add_f32 v171, v171, v187
  v_add_f32 v156, v156, v164
  v_add_f32 v157, v157, v165
  v_add_f32 v158, v158, v166
  v_add_f32 v159, v159, v167
  v_add_f32 v160, v160, v168
  v_add_f32 v161, v161, v169
  v_add_f32 v162, v162, v170
  v_add_f32 v163, v163, v171
  v_add_f32 v156, v156, v160
  v_add_f32 v157, v157, v161
  v_add_f32 v158, v158, v162
  v_add_f32 v159, v159, v163
  v_bfi_b32 v156, s78, v240, v156
  v_bfi_b32 v157, s78, v241, v157
  v_bfi_b32 v158, s78, v242, v158
  v_bfi_b32 v159, s78, v243, v159
  s_lshl_b32 s50, s54, 14
  s_add_u32 s50, s50, 12582912
  buffer_store_dwordx4 v[156:159], v1, s[24:27], s50 offen sc1
L_att_sm_11:
  ds_read_b64_tr_b16 v[16:17], v15 offset:16384
  ds_read_b64_tr_b16 v[18:19], v15 offset:16896
  ds_read_b64_tr_b16 v[20:21], v15 offset:18432
  ds_read_b64_tr_b16 v[22:23], v15 offset:18944
  ds_read_b64_tr_b16 v[24:25], v15 offset:20480
  ds_read_b64_tr_b16 v[26:27], v15 offset:20992
  ds_read_b64_tr_b16 v[28:29], v15 offset:22528
  ds_read_b64_tr_b16 v[30:31], v15 offset:23040
  ds_read_b64_tr_b16 v[32:33], v15 offset:0
  ds_read_b64_tr_b16 v[34:35], v15 offset:512
  ds_read_b64_tr_b16 v[36:37], v15 offset:2048
  ds_read_b64_tr_b16 v[38:39], v15 offset:2560
  s_waitcnt lgkmcnt(10)
  v_mfma_f32_32x32x16_bf16 v[156:171], v[16:19], v[44:47], 0
  ds_read_b64_tr_b16 v[16:17], v15 offset:4096
  ds_read_b64_tr_b16 v[18:19], v15 offset:4608
  s_waitcnt lgkmcnt(10)
  v_mfma_f32_32x32x16_bf16 v[156:171], v[20:23], v[48:51], v[156:171]
  ds_read_b64_tr_b16 v[20:21], v15 offset:6144
  ds_read_b64_tr_b16 v[22:23], v15 offset:6656
  s_waitcnt lgkmcnt(10)
  v_mfma_f32_32x32x16_bf16 v[156:171], v[24:27], v[52:55], v[156:171]
  ds_read_b64_tr_b16 v[24:25], v15 offset:8192
  ds_read_b64_tr_b16 v[26:27], v15 offset:8704
  s_waitcnt lgkmcnt(10)
  v_mfma_f32_32x32x16_bf16 v[156:171], v[28:31], v[56:59], v[156:171]
  ds_read_b64_tr_b16 v[28:29], v15 offset:10240
  ds_read_b64_tr_b16 v[30:31], v15 offset:10752
  s_waitcnt lgkmcnt(10)
  v_mfma_f32_32x32x16_bf16 v[156:171], v[32:35], v[60:63], v[156:171]
  ds_read_b64_tr_b16 v[32:33], v15 offset:12288
  ds_read_b64_tr_b16 v[34:35], v15 offset:12800
  s_waitcnt lgkmcnt(10)
  v_mfma_f32_32x32x16_bf16 v[156:171], v[36:39], v[64:67], v[156:171]
  ds_read_b64_tr_b16 v[36:37], v15 offset:14336
  ds_read_b64_tr_b16 v[38:39], v15 offset:14848
  s_waitcnt lgkmcnt(10)
  v_mfma_f32_32x32x16_bf16 v[156:171], v[16:19], v[68:71], v[156:171]
  ds_read_b64_tr_b16 v[16:17], v14 offset:57344
  ds_read_b64_tr_b16 v[18:19], v14 offset:57856
  s_waitcnt lgkmcnt(10)
  v_mfma_f32_32x32x16_bf16 v[156:171], v[20:23], v[72:75], v[156:171]
  ds_read_b64_tr_b16 v[20:21], v14 offset:59392
  ds_read_b64_tr_b16 v[22:23], v14 offset:59904
  s_waitcnt lgkmcnt(10)
  v_mfma_f32_32x32x16_bf16 v[156:171], v[24:27], v[76:79], v[156:171]
  ds_read_b64_tr_b16 v[24:25], v14 offset:61440
  ds_read_b64_tr_b16 v[26:27], v14 offset:61952
  s_waitcnt lgkmcnt(10)
  v_mfma_f32_32x32x16_bf16 v[156:171], v[28:31], v[80:83], v[156:171]
  ds_read_b64_tr_b16 v[28:29], v14 offset:63488
  ds_read_b64_tr_b16 v[30:31], v14 offset:64000
  s_waitcnt lgkmcnt(10)
  v_mfma_f32_32x32x16_bf16 v[156:171], v[32:35], v[84:87], v[156:171]
  ds_read_b64_tr_b16 v[32:33], v14 offset:49152
  ds_read_b64_tr_b16 v[34:35], v14 offset:49664
  s_waitcnt lgkmcnt(10)
  v_mfma_f32_32x32x16_bf16 v[156:171], v[36:39], v[88:91], v[156:171]
  ds_read_b64_tr_b16 v[36:37], v14 offset:51200
  ds_read_b64_tr_b16 v[38:39], v14 offset:51712
  s_waitcnt lgkmcnt(10)
  v_mfma_f32_32x32x16_bf16 v[156:171], v[16:19], v[92:95], v[156:171]
  ds_read_b64_tr_b16 v[16:17], v14 offset:53248
  ds_read_b64_tr_b16 v[18:19], v14 offset:53760
  s_waitcnt lgkmcnt(10)
  v_mfma_f32_32x32x16_bf16 v[156:171], v[20:23], v[96:99], v[156:171]
  ds_read_b64_tr_b16 v[20:21], v14 offset:55296
  ds_read_b64_tr_b16 v[22:23], v14 offset:55808
  s_waitcnt lgkmcnt(10)
  v_mfma_f32_32x32x16_bf16 v[156:171], v[24:27], v[100:103], v[156:171]
  ds_read_b64_tr_b16 v[24:25], v14 offset:40960
  ds_read_b64_tr_b16 v[26:27], v14 offset:41472
  s_waitcnt lgkmcnt(10)
  v_mfma_f32_32x32x16_bf16 v[156:171], v[28:31], v[104:107], v[156:171]
  ds_read_b64_tr_b16 v[28:29], v14 offset:43008
  ds_read_b64_tr_b16 v[30:31], v14 offset:43520
  s_waitcnt lgkmcnt(10)
  v_mfma_f32_32x32x16_bf16 v[156:171], v[32:35], v[108:111], v[156:171]
  ds_read_b64_tr_b16 v[32:33], v14 offset:45056
  ds_read_b64_tr_b16 v[34:35], v14 offset:45568
  s_waitcnt lgkmcnt(10)
  v_mfma_f32_32x32x16_bf16 v[156:171], v[36:39], v[112:115], v[156:171]
  ds_read_b64_tr_b16 v[36:37], v14 offset:47104
  ds_read_b64_tr_b16 v[38:39], v14 offset:47616
  s_waitcnt lgkmcnt(10)
  v_mfma_f32_32x32x16_bf16 v[156:171], v[16:19], v[116:119], v[156:171]
  ds_read_b64_tr_b16 v[16:17], v14 offset:32768
  ds_read_b64_tr_b16 v[18:19], v14 offset:33280
  s_waitcnt lgkmcnt(10)
  v_mfma_f32_32x32x16_bf16 v[156:171], v[20:23], v[120:123], v[156:171]
  ds_read_b64_tr_b16 v[20:21], v14 offset:34816
  ds_read_b64_tr_b16 v[22:23], v14 offset:35328
  s_waitcnt lgkmcnt(10)
  v_mfma_f32_32x32x16_bf16 v[156:171], v[24:27], v[124:127], v[156:171]
  ds_read_b64_tr_b16 v[24:25], v14 offset:36864
  ds_read_b64_tr_b16 v[26:27], v14 offset:37376
  s_waitcnt lgkmcnt(10)
  v_mfma_f32_32x32x16_bf16 v[156:171], v[28:31], v[128:131], v[156:171]
  ds_read_b64_tr_b16 v[28:29], v14 offset:38912
  ds_read_b64_tr_b16 v[30:31], v14 offset:39424
  s_waitcnt lgkmcnt(10)
  v_mfma_f32_32x32x16_bf16 v[156:171], v[32:35], v[132:135], v[156:171]
  s_waitcnt lgkmcnt(8)
  v_mfma_f32_32x32x16_bf16 v[156:171], v[36:39], v[136:139], v[156:171]
  s_waitcnt lgkmcnt(6)
  v_mfma_f32_32x32x16_bf16 v[156:171], v[16:19], v[140:143], v[156:171]
  s_waitcnt lgkmcnt(4)
  v_mfma_f32_32x32x16_bf16 v[156:171], v[20:23], v[144:147], v[156:171]
  s_waitcnt lgkmcnt(2)
  v_mfma_f32_32x32x16_bf16 v[156:171], v[24:27], v[148:151], v[156:171]
  s_waitcnt lgkmcnt(0)
  v_mfma_f32_32x32x16_bf16 v[156:171], v[28:31], v[152:155], v[156:171]
  s_nop 11
  v_cvt_pk_bf16_f32 v204, v156, v157
  v_cvt_pk_bf16_f32 v205, v158, v159
  v_cvt_pk_bf16_f32 v206, v160, v161
  v_cvt_pk_bf16_f32 v207, v162, v163
  v_cvt_pk_bf16_f32 v208, v164, v165
  v_cvt_pk_bf16_f32 v209, v166, v167
  v_cvt_pk_bf16_f32 v210, v168, v169
  v_cvt_pk_bf16_f32 v211, v170, v171
  s_barrier
  v_readlane_b32 s94, v250, 0
  s_add_u32 m0, s87, 0
  s_nop 3
  buffer_load_dwordx4 v245, s[16:19], s94 offen lds
  v_readlane_b32 s95, v250, 1
  s_add_u32 m0, s87, 8192
  s_nop 3
  buffer_load_dwordx4 v245, s[16:19], s95 offen lds
  v_readlane_b32 s94, v250, 2
  s_add_u32 m0, s87, 16384
  s_nop 3
  buffer_load_dwordx4 v245, s[16:19], s94 offen lds
  v_readlane_b32 s95, v250, 3
  s_add_u32 m0, s87, 24576
  s_nop 3
  buffer_load_dwordx4 v245, s[16:19], s95 offen lds
  v_readlane_b32 s94, v250, 4
  s_add_u32 m0, s87, 32768
  s_nop 3
  buffer_load_dwordx4 v245, s[16:19], s94 offen lds
  v_readlane_b32 s95, v250, 5
  s_add_u32 m0, s87, 40960
  s_nop 3
  buffer_load_dwordx4 v245, s[16:19], s95 offen lds
  v_mfma_f32_32x32x16_bf16 v[172:187], v[220:223], v[204:207], 0
  v_mfma_f32_32x32x16_bf16 v[172:187], v[224:227], v[208:211], v[172:187]
  s_nop 11
  v_cndmask_b32 v200, v184, v8, s[60:61]
  v_cndmask_b32 v216, v184, v9, s[60:61]
  v_cndmask_b32 v201, v185, v8, s[60:61]
  v_cndmask_b32 v217, v185, v9, s[60:61]
  v_cndmask_b32 v202, v186, v8, s[60:61]
  v_cndmask_b32 v218, v186, v9, s[60:61]
  v_cndmask_b32 v203, v187, v8, s[60:61]
  v_cndmask_b32 v219, v187, v9, s[60:61]
  v_max3_f32 v236, v172, v173, v174
  v_min3_f32 v237, v172, v173, v174
  v_max3_f32 v238, v175, v176, v177
  v_min3_f32 v239, v175, v176, v177
  v_max3_f32 v236, v236, v178, v179
  v_min3_f32 v237, v237, v178, v179
  v_max3_f32 v238, v238, v180, v181
  v_min3_f32 v239, v239, v180, v181
  v_max3_f32 v236, v236, v182, v183
  v_min3_f32 v237, v237, v182, v183
  v_max3_f32 v238, v238, v200, v201
  v_min3_f32 v239, v239, v216, v217
  v_max3_f32 v236, v236, v202, v203
  v_min3_f32 v237, v237, v218, v219
  v_max_f32 v236, v236, v238
  v_min_f32 v237, v237, v239
  v_mov_b32 v238, v236
  v_mov_b32 v239, v237
  s_nop 0
  v_permlane32_swap_b32 v236, v238
  v_permlane32_swap_b32 v237, v239
  v_max_f32 v236, v236, v238
  v_min_f32 v237, v237, v239
  v_mul_f32 v236, s62, v236
  v_mul_f32 v237, s62, v237
  v_fma_f32 v188, v172, s62, -v236
  v_fma_f32 v204, v172, s63, v237
  v_fma_f32 v189, v173, s62, -v236
  v_fma_f32 v205, v173, s63, v237
  v_fma_f32 v190, v174, s62, -v236
  v_fma_f32 v206, v174, s63, v237
  v_fma_f32 v191, v175, s62, -v236
  v_fma_f32 v207, v175, s63, v237
  v_fma_f32 v192, v176, s62, -v236
  v_fma_f32 v208, v176, s63, v237
  v_fma_f32 v193, v177, s62, -v236
  v_fma_f32 v209, v177, s63, v237
  v_fma_f32 v194, v178, s62, -v236
  v_fma_f32 v210, v178, s63, v237
  v_fma_f32 v195, v179, s62, -v236
  v_fma_f32 v211, v179, s63, v237
  v_fma_f32 v196, v180, s62, -v236
  v_fma_f32 v212, v180, s63, v237
  v_fma_f32 v197, v181, s62, -v236
  v_fma_f32 v213, v181, s63, v237
  v_fma_f32 v198, v182, s62, -v236
  v_fma_f32 v214, v182, s63, v237
  v_fma_f32 v199, v183, s62, -v236
  v_fma_f32 v215, v183, s63, v237
  v_fma_f32 v200, v200, s62, -v236
  v_fma_f32 v216, v216, s63, v237
  v_fma_f32 v201, v201, s62, -v236
  v_fma_f32 v217, v217, s63, v237
  v_fma_f32 v202, v202, s62, -v236
  v_fma_f32 v218, v218, s63, v237
  v_fma_f32 v203, v203, s62, -v236
  v_fma_f32 v219, v219, s63, v237
  v_exp_f32 v188, v188
  v_exp_f32 v204, v204
  v_exp_f32 v189, v189
  v_exp_f32 v205, v205
  v_exp_f32 v190, v190
  v_exp_f32 v206, v206
  v_exp_f32 v191, v191
  v_exp_f32 v207, v207
  v_exp_f32 v192, v192
  v_exp_f32 v208, v208
  v_exp_f32 v193, v193
  v_exp_f32 v209, v209
  v_exp_f32 v194, v194
  v_exp_f32 v210, v210
  v_exp_f32 v195, v195
  v_exp_f32 v211, v211
  v_exp_f32 v196, v196
  v_exp_f32 v212, v212
  v_exp_f32 v197, v197
  v_exp_f32 v213, v213
  v_exp_f32 v198, v198
  v_exp_f32 v214, v214
  v_exp_f32 v199, v199
  v_exp_f32 v215, v215
  v_exp_f32 v200, v200
  v_exp_f32 v216, v216
  v_exp_f32 v201, v201
  v_exp_f32 v217, v217
  v_exp_f32 v202, v202
  v_exp_f32 v218, v218
  v_exp_f32 v203, v203
  v_exp_f32 v219, v219
  v_add_f32 v236, v188, v189
  v_add_f32 v237, v204, v205
  v_add_f32 v238, v190, v191
  v_add_f32 v239, v206, v207
  v_add_f32 v236, v236, v192
  v_add_f32 v237, v237, v208
  v_add_f32 v238, v238, v193
  v_add_f32 v239, v239, v209
  v_add_f32 v236, v236, v194
  v_add_f32 v237, v237, v210
  v_add_f32 v238, v238, v195
  v_add_f32 v239, v239, v211
  v_add_f32 v236, v236, v196
  v_add_f32 v237, v237, v212
  v_add_f32 v238, v238, v197
  v_add_f32 v239, v239, v213
  v_add_f32 v236, v236, v198
  v_add_f32 v237, v237, v214
  v_add_f32 v238, v238, v199
  v_add_f32 v239, v239, v215
  v_add_f32 v236, v236, v200
  v_add_f32 v237, v237, v216
  v_add_f32 v238, v238, v201
  v_add_f32 v239, v239, v217
  v_add_f32 v236, v236, v202
  v_add_f32 v237, v237, v218
  v_add_f32 v238, v238, v203
  v_add_f32 v239, v239, v219
  v_add_f32 v236, v236, v238
  v_add_f32 v237, v237, v239
  v_mov_b32 v238, v236
  v_mov_b32 v239, v237
  s_nop 0
  v_permlane32_swap_b32 v236, v238
  v_permlane32_swap_b32 v237, v239
  v_add_f32 v236, v236, v238
  v_add_f32 v237, v237, v239
  v_rcp_f32 v236, v236
  v_rcp_f32 v237, v237
  v_mul_f32 v188, v188, v236
  v_mul_f32 v204, v204, v237
  v_mul_f32 v189, v189, v236
  v_mul_f32 v205, v205, v237
  v_mul_f32 v190, v190, v236
  v_mul_f32 v206, v206, v237
  v_mul_f32 v191, v191, v236
  v_mul_f32 v207, v207, v237
  v_mul_f32 v192, v192, v236
  v_mul_f32 v208, v208, v237
  v_mul_f32 v193, v193, v236
  v_mul_f32 v209, v209, v237
  v_mul_f32 v194, v194, v236
  v_mul_f32 v210, v210, v237
  v_mul_f32 v195, v195, v236
  v_mul_f32 v211, v211, v237
  v_mul_f32 v196, v196, v236
  v_mul_f32 v212, v212, v237
  v_mul_f32 v197, v197, v236
  v_mul_f32 v213, v213, v237
  v_mul_f32 v198, v198, v236
  v_mul_f32 v214, v214, v237
  v_mul_f32 v199, v199, v236
  v_mul_f32 v215, v215, v237
  v_mul_f32 v200, v200, v236
  v_mul_f32 v216, v216, v237
  v_mul_f32 v201, v201, v236
  v_mul_f32 v217, v217, v237
  v_mul_f32 v202, v202, v236
  v_mul_f32 v218, v218, v237
  v_mul_f32 v203, v203, v236
  v_mul_f32 v219, v219, v237
  v_cvt_pk_bf16_f32 v172, v188, v189
  v_cvt_pk_bf16_f32 v180, v204, v205
  v_cvt_pk_bf16_f32 v173, v190, v191
  v_cvt_pk_bf16_f32 v181, v206, v207
  v_cvt_pk_bf16_f32 v174, v192, v193
  v_cvt_pk_bf16_f32 v182, v208, v209
  v_cvt_pk_bf16_f32 v175, v194, v195
  v_cvt_pk_bf16_f32 v183, v210, v211
  v_cvt_pk_bf16_f32 v176, v196, v197
  v_cvt_pk_bf16_f32 v184, v212, v213
  v_cvt_pk_bf16_f32 v177, v198, v199
  v_cvt_pk_bf16_f32 v185, v214, v215
  v_cvt_pk_bf16_f32 v178, v200, v201
  v_cvt_pk_bf16_f32 v186, v216, v217
  v_cvt_pk_bf16_f32 v179, v202, v203
  v_cvt_pk_bf16_f32 v187, v218, v219
  s_cmp_lt_u32 s89, 28
  s_cbranch_scc1 L_phase2_att
  s_lshl_b32 s50, s45, 14
  s_and_b32 s51, s3, 4
  s_lshl_b32 s51, s51, 11
  s_add_u32 s50, s50, s51
  s_add_u32 s50, s50, 12582912
  v_lshlrev_b32 v1, 4, v0
  buffer_load_dwordx4 v[60:63], v1, s[24:27], s50 offen offset:0 sc1
  buffer_load_dwordx4 v[64:67], v1, s[24:27], s50 offen offset:1024 sc1
  s_add_u32 s50, s50, 2048
  buffer_load_dwordx4 v[68:71], v1, s[24:27], s50 offen offset:0 sc1
  buffer_load_dwordx4 v[72:75], v1, s[24:27], s50 offen offset:1024 sc1
  s_add_u32 s50, s50, 2048
  buffer_load_dwordx4 v[76:79], v1, s[24:27], s50 offen offset:0 sc1
  buffer_load_dwordx4 v[80:83], v1, s[24:27], s50 offen offset:1024 sc1
  s_add_u32 s50, s50, 2048
  buffer_load_dwordx4 v[84:87], v1, s[24:27], s50 offen offset:0 sc1
  buffer_load_dwordx4 v[88:91], v1, s[24:27], s50 offen offset:1024 sc1
  s_waitcnt vmcnt(0)
  s_mov_b32 s88, 0x40000
L_fre_16:
  v_mov_b32 v2, 0
  v_perm_b32 v3, v61, v60, s4
  v_perm_b32 v4, v63, v62, s5
  v_add3_u32 v3, v3, v4, s79
  v_or_b32 v2, v2, v3
  v_perm_b32 v3, v65, v64, s4
  v_perm_b32 v4, v67, v66, s5
  v_add3_u32 v3, v3, v4, s79
  v_or_b32 v2, v2, v3
  v_perm_b32 v3, v69, v68, s4
  v_perm_b32 v4, v71, v70, s5
  v_add3_u32 v3, v3, v4, s79
  v_or_b32 v2, v2, v3
  v_perm_b32 v3, v73, v72, s4
  v_perm_b32 v4, v75, v74, s5
  v_add3_u32 v3, v3, v4, s79
  v_or_b32 v2, v2, v3
  v_perm_b32 v3, v77, v76, s4
  v_perm_b32 v4, v79, v78, s5
  v_add3_u32 v3, v3, v4, s79
  v_or_b32 v2, v2, v3
  v_perm_b32 v3, v81, v80, s4
  v_perm_b32 v4, v83, v82, s5
  v_add3_u32 v3, v3, v4, s79
  v_or_b32 v2, v2, v3
  v_perm_b32 v3, v85, v84, s4
  v_perm_b32 v4, v87, v86, s5
  v_add3_u32 v3, v3, v4, s79
  v_or_b32 v2, v2, v3
  v_perm_b32 v3, v89, v88, s4
  v_perm_b32 v4, v91, v90, s5
  v_add3_u32 v3, v3, v4, s79
  v_or_b32 v2, v2, v3
  v_cmp_ne_u32 vcc, 0, v2
  s_nop 0
  s_cmp_eq_u64 vcc, 0
  s_nop 1
  s_cbranch_scc1 L_fok_15
  s_sub_u32 s88, s88, 1
  s_cmp_eq_u32 s88, 0
  s_cbranch_scc1 L_fok_15
  s_lshl_b32 s50, s45, 14
  s_and_b32 s51, s3, 4
  s_lshl_b32 s51, s51, 11
  s_add_u32 s50, s50, s51
  s_add_u32 s50, s50, 12582912
  v_lshlrev_b32 v1, 4, v0
  buffer_load_dwordx4 v[60:63], v1, s[24:27], s50 offen offset:0 sc1
  buffer_load_dwordx4 v[64:67], v1, s[24:27], s50 offen offset:1024 sc1
  s_add_u32 s50, s50, 2048
  buffer_load_dwordx4 v[68:71], v1, s[24:27], s50 offen offset:0 sc1
  buffer_load_dwordx4 v[72:75], v1, s[24:27], s50 offen offset:1024 sc1
  s_add_u32 s50, s50, 2048
  buffer_load_dwordx4 v[76:79], v1, s[24:27], s50 offen offset:0 sc1
  buffer_load_dwordx4 v[80:83], v1, s[24:27], s50 offen offset:1024 sc1
  s_add_u32 s50, s50, 2048
  buffer_load_dwordx4 v[84:87], v1, s[24:27], s50 offen offset:0 sc1
  buffer_load_dwordx4 v[88:91], v1, s[24:27], s50 offen offset:1024 sc1
  s_waitcnt vmcnt(0)
  s_branch L_fre_16
L_fok_15:
  v_cvt_pk_bf16_f32 v188, v60, v61
  v_cvt_pk_bf16_f32 v189, v62, v63
  v_cvt_pk_bf16_f32 v190, v64, v65
  v_cvt_pk_bf16_f32 v191, v66, v67
  v_cvt_pk_bf16_f32 v192, v68, v69
  v_cvt_pk_bf16_f32 v193, v70, v71
  v_cvt_pk_bf16_f32 v194, v72, v73
  v_cvt_pk_bf16_f32 v195, v74, v75
  v_cvt_pk_bf16_f32 v196, v76, v77
  v_cvt_pk_bf16_f32 v197, v78, v79
  v_cvt_pk_bf16_f32 v198, v80, v81
  v_cvt_pk_bf16_f32 v199, v82, v83
  v_cvt_pk_bf16_f32 v200, v84, v85
  v_cvt_pk_bf16_f32 v201, v86, v87
  v_cvt_pk_bf16_f32 v202, v88, v89
  v_cvt_pk_bf16_f32 v203, v90, v91
  v_mfma_f32_32x32x16_bf16 v[156:171], v[188:191], v[172:175], 0
  v_mfma_f32_32x32x16_bf16 v[156:171], v[192:195], v[176:179], v[156:171]
  v_mfma_f32_32x32x16_bf16 v[156:171], v[196:199], v[180:183], v[156:171]
  v_mfma_f32_32x32x16_bf16 v[156:171], v[200:203], v[184:187], v[156:171]
  s_lshl_b32 s50, s44, 2
  s_and_b32 s51, s3, 3
  s_add_u32 s50, s50, s51
  s_mul_i32 s50, s50, 144
  s_lshl_b32 s51, s45, 2
  s_add_u32 s50, s50, s51
  s_lshr_b32 s51, s3, 2
  s_lshl_b32 s51, s51, 1
  s_add_u32 s50, s50, s51
  s_add_u32 s50, s50, 112
  s_lshl_b32 s50, s50, 10
  s_nop 0
  v_mov_b32 v3, v168
  v_mov_b32 v4, v168
  s_nop 1
  v_permlane32_swap_b32 v3, v4
  v_add_f32 v4, 0x358637bd, v4
  v_rcp_f32 v4, v4
  s_nop 0
  v_mul_f32 v156, v156, v4
  v_mul_f32 v157, v157, v4
  v_mul_f32 v158, v158, v4
  v_mul_f32 v159, v159, v4
  v_mul_f32 v160, v160, v4
  v_mul_f32 v161, v161, v4
  v_mul_f32 v162, v162, v4
  v_mul_f32 v163, v163, v4
  v_mul_f32 v164, v164, v4
  v_mul_f32 v165, v165, v4
  v_mul_f32 v166, v166, v4
  v_mul_f32 v167, v167, v4
  v_mul_f32 v168, v168, v4
  v_mul_f32 v169, v169, v4
  v_mul_f32 v170, v170, v4
  v_mul_f32 v171, v171, v4
  v_cndmask_b32 v168, v168, 0, s[60:61]
  v_cndmask_b32 v169, v169, 0, s[60:61]
  v_cndmask_b32 v170, v170, 0, s[60:61]
  v_cndmask_b32 v171, v171, 0, s[60:61]
  v_cvt_pk_bf16_f32 v204, v156, v157
  v_cvt_pk_bf16_f32 v205, v158, v159
  v_cvt_pk_bf16_f32 v206, v160, v161
  v_cvt_pk_bf16_f32 v207, v162, v163
  v_cvt_pk_bf16_f32 v208, v164, v165
  v_cvt_pk_bf16_f32 v209, v166, v167
  v_cvt_pk_bf16_f32 v210, v168, v169
  v_cvt_pk_bf16_f32 v211, v170, v171
  v_lshlrev_b32 v1, 4, v0
  buffer_store_dwordx4 v[204:207], v1, s[24:27], s50 offen sc1
  buffer_store_dwordx4 v[208:211], v1, s[24:27], s50 offen offset:1024 sc1
  s_waitcnt vmcnt(0)
  s_barrier
  s_lshl_b32 s51, s44, 7
  s_lshl_b32 s52, s45, 2
  s_add_u32 s51, s51, s52
  s_add_u32 s51, s51, 13634560
  s_cmp_lg_u32 s3, 0
  s_cbranch_scc1 L_noflag_17
  v_mov_b32 v3, s48
  v_mov_b32 v2, 0
  s_mov_b64 exec, 1
  buffer_store_dword v3, v2, s[24:27], s51 offen sc1
  s_mov_b64 exec, -1
L_noflag_17:
  s_branch L_fin
L_phase2_ffn:
  s_cmp_lg_u32 s3, 0
  s_cbranch_scc1 L_g1w_18
  s_lshr_b32 s51, s46, 1
  s_lshl_b32 s51, s51, 7
  s_add_u32 s51, s51, 13631488
  v_and_b32 v3, 14, v0
  v_lshlrev_b32 v3, 3, v3
  v_and_b32 v2, 1, v0
  v_lshl_add_u32 v3, v2, 2, v3
  s_mov_b32 s88, 0x40000
L_spp_20:
  buffer_load_dword v113, v3, s[24:27], s51 offen sc1
  s_waitcnt vmcnt(0)
  v_cmp_ne_u32 vcc, s48, v113
  s_sub_u32 s88, s88, 1
  s_cmp_eq_u32 s88, 0
  s_nop 1
  s_cbranch_scc1 L_spok_19
  s_cmp_eq_u64 vcc, 0
  s_cbranch_scc0 L_spp_20
L_spok_19:
L_g1w_18:
  v_readlane_b32 s94, v250, 0
  s_add_u32 m0, s87, 0
  s_nop 3
  buffer_load_dwordx4 v245, s[16:19], s94 offen lds
  v_readlane_b32 s95, v250, 1
  s_add_u32 m0, s87, 8192
  s_nop 3
  buffer_load_dwordx4 v245, s[16:19], s95 offen lds
  v_readlane_b32 s94, v250, 2
  s_add_u32 m0, s87, 16384
  s_nop 3
  buffer_load_dwordx4 v245, s[16:19], s94 offen lds
  v_readlane_b32 s95, v250, 3
  s_add_u32 m0, s87, 24576
  s_nop 3
  buffer_load_dwordx4 v245, s[16:19], s95 offen lds
  v_readlane_b32 s94, v250, 4
  s_add_u32 m0, s87, 32768
  s_nop 3
  buffer_load_dwordx4 v245, s[16:19], s94 offen lds
  v_readlane_b32 s95, v250, 5
  s_add_u32 m0, s87, 40960
  s_nop 3
  buffer_load_dwordx4 v245, s[16:19], s95 offen lds
  v_readlane_b32 s94, v250, 6
  s_add_u32 m0, s87, 49152
  s_nop 3
  buffer_load_dwordx4 v245, s[16:19], s94 offen lds
  v_readlane_b32 s95, v250, 7
  s_add_u32 m0, s87, 57344
  s_nop 3
  buffer_load_dwordx4 v245, s[16:19], s95 offen lds
  s_barrier
  v_readlane_b32 s96, v251, 0
  s_add_u32 m0, s87, 98304
  s_nop 3
  buffer_load_dwordx4 v244, s[24:27], s96 offen sc1 lds
  v_readlane_b32 s97, v251, 1
  s_add_u32 m0, s87, 106496
  s_nop 3
  buffer_load_dwordx4 v244, s[24:27], s97 offen sc1 lds
  v_readlane_b32 s96, v251, 2
  s_add_u32 m0, s87, 114688
  s_nop 3
  buffer_load_dwordx4 v244, s[24:27], s96 offen sc1 lds
  v_readlane_b32 s97, v251, 3
  s_add_u32 m0, s87, 122880
  s_nop 3
  buffer_load_dwordx4 v244, s[24:27], s97 offen sc1 lds
  v_readlane_b32 s96, v251, 4
  s_add_u32 m0, s87, 131072
  s_nop 3
  buffer_load_dwordx4 v244, s[24:27], s96 offen sc1 lds
  v_readlane_b32 s97, v251, 5
  s_add_u32 m0, s87, 139264
  s_nop 3
  buffer_load_dwordx4 v244, s[24:27], s97 offen sc1 lds
  v_readlane_b32 s94, v250, 8
  s_add_u32 m0, s87, 65536
  s_nop 3
  buffer_load_dwordx4 v245, s[16:19], s94 offen lds
  v_readlane_b32 s95, v250, 9
  s_add_u32 m0, s87, 73728
  s_nop 3
  buffer_load_dwordx4 v245, s[16:19], s95 offen lds
  v_readlane_b32 s94, v250, 10
  s_add_u32 m0, s87, 81920
  s_nop 3
  buffer_load_dwordx4 v245, s[16:19], s94 offen lds
  v_readlane_b32 s95, v250, 11
  s_add_u32 m0, s87, 90112
  s_nop 3
  buffer_load_dwordx4 v245, s[16:19], s95 offen lds
  s_waitcnt vmcnt(9)
  s_barrier
  ds_read_b128 v[32:35], v246 offset:0
  ds_read_b64_tr_b16 v[48:49], v247 offset:0
  ds_read_b64_tr_b16 v[50:51], v247 offset:1024
  ds_read_b128 v[36:39], v246 offset:1024
  ds_read_b64_tr_b16 v[52:53], v247 offset:2048
  ds_read_b64_tr_b16 v[54:55], v247 offset:3072
  s_waitcnt lgkmcnt(3)
  v_mfma_f32_32x32x16_bf16 v[16:31], v[48:51], v[32:35], 0
  s_waitcnt lgkmcnt(0)
  v_mfma_f32_32x32x16_bf16 v[16:31], v[52:55], v[36:39], v[16:31]
  s_waitcnt vmcnt(8)
  s_barrier
  ds_read_b128 v[32:35], v246 offset:8192
  ds_read_b64_tr_b16 v[48:49], v247 offset:8192
  ds_read_b64_tr_b16 v[50:51], v247 offset:9216
  ds_read_b128 v[36:39], v246 offset:9216
  ds_read_b64_tr_b16 v[52:53], v247 offset:10240
  ds_read_b64_tr_b16 v[54:55], v247 offset:11264
  v_readlane_b32 s94, v250, 12
  s_add_u32 m0, s87, 0
  s_nop 3
  buffer_load_dwordx4 v245, s[16:19], s94 offen lds
  v_readlane_b32 s96, v251, 6
  s_add_u32 m0, s87, 147456
  s_nop 3
  buffer_load_dwordx4 v244, s[24:27], s96 offen sc1 lds
  s_waitcnt lgkmcnt(3)
  v_mfma_f32_32x32x16_bf16 v[16:31], v[48:51], v[32:35], v[16:31]
  s_waitcnt lgkmcnt(0)
  v_mfma_f32_32x32x16_bf16 v[16:31], v[52:55], v[36:39], v[16:31]
  s_waitcnt vmcnt(9)
  s_barrier
  ds_read_b128 v[32:35], v246 offset:16384
  ds_read_b64_tr_b16 v[48:49], v247 offset:16384
  ds_read_b64_tr_b16 v[50:51], v247 offset:17408
  ds_read_b128 v[36:39], v246 offset:17408
  ds_read_b64_tr_b16 v[52:53], v247 offset:18432
  ds_read_b64_tr_b16 v[54:55], v247 offset:19456
  v_readlane_b32 s95, v250, 13
  s_add_u32 m0, s87, 8192
  s_nop 3
  buffer_load_dwordx4 v245, s[16:19], s95 offen lds
  v_readlane_b32 s97, v251, 7
  s_add_u32 m0, s87, 98304
  s_nop 3
  buffer_load_dwordx4 v244, s[24:27], s97 offen sc1 lds
  s_waitcnt lgkmcnt(3)
  v_mfma_f32_32x32x16_bf16 v[16:31], v[48:51], v[32:35], v[16:31]
  s_waitcnt lgkmcnt(0)
  v_mfma_f32_32x32x16_bf16 v[16:31], v[52:55], v[36:39], v[16:31]
  s_waitcnt vmcnt(10)
  s_barrier
  ds_read_b128 v[32:35], v246 offset:24576
  ds_read_b64_tr_b16 v[48:49], v247 offset:24576
  ds_read_b64_tr_b16 v[50:51], v247 offset:25600
  ds_read_b128 v[36:39], v246 offset:25600
  ds_read_b64_tr_b16 v[52:53], v247 offset:26624
  ds_read_b64_tr_b16 v[54:55], v247 offset:27648
  v_readlane_b32 s94, v250, 14
  s_add_u32 m0, s87, 16384
  s_nop 3
  buffer_load_dwordx4 v245, s[16:19], s94 offen lds
  v_readlane_b32 s96, v251, 8
  s_add_u32 m0, s87, 106496
  s_nop 3
  buffer_load_dwordx4 v244, s[24:27], s96 offen sc1 lds
  s_waitcnt lgkmcnt(3)
  v_mfma_f32_32x32x16_bf16 v[16:31], v[48:51], v[32:35], v[16:31]
  s_waitcnt lgkmcnt(0)
  v_mfma_f32_32x32x16_bf16 v[16:31], v[52:55], v[36:39], v[16:31]
  s_waitcnt vmcnt(11)
  s_barrier
  ds_read_b128 v[32:35], v246 offset:32768
  ds_read_b64_tr_b16 v[48:49], v247 offset:32768
  ds_read_b64_tr_b16 v[50:51], v247 offset:33792
  ds_read_b128 v[36:39], v246 offset:33792
  ds_read_b64_tr_b16 v[52:53], v247 offset:34816
  ds_read_b64_tr_b16 v[54:55], v247 offset:35840
  v_readlane_b32 s95, v250, 15
  s_add_u32 m0, s87, 24576
  s_nop 3
  buffer_load_dwordx4 v245, s[16:19], s95 offen lds
  v_readlane_b32 s97, v251, 9
  s_add_u32 m0, s87, 114688
  s_nop 3
  buffer_load_dwordx4 v244, s[24:27], s97 offen sc1 lds
  s_waitcnt lgkmcnt(3)
  v_mfma_f32_32x32x16_bf16 v[16:31], v[48:51], v[32:35], v[16:31]
  s_waitcnt lgkmcnt(0)
  v_mfma_f32_32x32x16_bf16 v[16:31], v[52:55], v[36:39], v[16:31]
  s_waitcnt vmcnt(12)
  s_barrier
  ds_read_b128 v[32:35], v246 offset:40960
  ds_read_b64_tr_b16 v[48:49], v247 offset:40960
  ds_read_b64_tr_b16 v[50:51], v247 offset:41984
  ds_read_b128 v[36:39], v246 offset:41984
  ds_read_b64_tr_b16 v[52:53], v247 offset:43008
  ds_read_b64_tr_b16 v[54:55], v247 offset:44032
  v_readlane_b32 s94, v250, 16
  s_add_u32 m0, s87, 32768
  s_nop 3
  buffer_load_dwordx4 v245, s[16:19], s94 offen lds
  v_readlane_b32 s96, v251, 10
  s_add_u32 m0, s87, 122880
  s_nop 3
  buffer_load_dwordx4 v244, s[24:27], s96 offen sc1 lds
  s_waitcnt lgkmcnt(3)
  v_mfma_f32_32x32x16_bf16 v[16:31], v[48:51], v[32:35], v[16:31]
  s_waitcnt lgkmcnt(0)
  v_mfma_f32_32x32x16_bf16 v[16:31], v[52:55], v[36:39], v[16:31]
  s_waitcnt vmcnt(8)
  s_barrier
  ds_read_b128 v[32:35], v246 offset:49152
  ds_read_b64_tr_b16 v[48:49], v247 offset:49152
  ds_read_b64_tr_b16 v[50:51], v247 offset:50176
  ds_read_b128 v[36:39], v246 offset:50176
  ds_read_b64_tr_b16 v[52:53], v247 offset:51200
  ds_read_b64_tr_b16 v[54:55], v247 offset:52224
  v_readlane_b32 s95, v250, 17
  s_add_u32 m0, s87, 40960
  s_nop 3
  buffer_load_dwordx4 v245, s[16:19], s95 offen lds
  v_readlane_b32 s97, v251, 11
  s_add_u32 m0, s87, 131072
  s_nop 3
  buffer_load_dwordx4 v244, s[24:27], s97 offen sc1 lds
  s_waitcnt lgkmcnt(3)
  v_mfma_f32_32x32x16_bf16 v[16:31], v[48:51], v[32:35], v[16:31]
  s_waitcnt lgkmcnt(0)
  v_mfma_f32_32x32x16_bf16 v[16:31], v[52:55], v[36:39], v[16:31]
  s_waitcnt vmcnt(8)
  s_barrier
  ds_read_b128 v[32:35], v246 offset:0
  ds_read_b64_tr_b16 v[48:49], v247 offset:57344
  ds_read_b64_tr_b16 v[50:51], v247 offset:58368
  ds_read_b128 v[36:39], v246 offset:1024
  ds_read_b64_tr_b16 v[52:53], v247 offset:59392
  ds_read_b64_tr_b16 v[54:55], v247 offset:60416
  v_readlane_b32 s94, v250, 18
  s_add_u32 m0, s87, 49152
  s_nop 3
  buffer_load_dwordx4 v245, s[16:19], s94 offen lds
  v_readlane_b32 s96, v251, 12
  s_add_u32 m0, s87, 139264
  s_nop 3
  buffer_load_dwordx4 v244, s[24:27], s96 offen sc1 lds
  s_waitcnt lgkmcnt(3)
  v_mfma_f32_32x32x16_bf16 v[16:31], v[48:51], v[32:35], v[16:31]
  s_waitcnt lgkmcnt(0)
  v_mfma_f32_32x32x16_bf16 v[16:31], v[52:55], v[36:39], v[16:31]
  s_waitcnt vmcnt(8)
  s_barrier
  ds_read_b128 v[32:35], v246 offset:8192
  ds_read_b64_tr_b16 v[48:49], v249 offset:0
  ds_read_b64_tr_b16 v[50:51], v249 offset:1024
  ds_read_b128 v[36:39], v246 offset:9216
  ds_read_b64_tr_b16 v[52:53], v249 offset:2048
  ds_read_b64_tr_b16 v[54:55], v249 offset:3072
  v_readlane_b32 s95, v250, 19
  s_add_u32 m0, s87, 57344
  s_nop 3
  buffer_load_dwordx4 v245, s[16:19], s95 offen lds
  s_lshr_b32 s51, s46, 1
  s_lshl_b32 s51, s51, 7
  s_add_u32 s51, s51, 13893632
  v_and_b32 v3, 14, v0
  v_lshlrev_b32 v3, 3, v3
  v_and_b32 v2, 1, v0
  v_lshl_add_u32 v3, v2, 2, v3
  buffer_load_dword v113, v3, s[24:27], s51 offen sc1
  v_readlane_b32 s97, v251, 13
  s_add_u32 m0, s87, 147456
  s_nop 3
  buffer_load_dwordx4 v244, s[24:27], s97 offen sc1 lds
  s_waitcnt lgkmcnt(3)
  v_mfma_f32_32x32x16_bf16 v[16:31], v[48:51], v[32:35], v[16:31]
  s_waitcnt lgkmcnt(0)
  v_mfma_f32_32x32x16_bf16 v[16:31], v[52:55], v[36:39], v[16:31]
  s_waitcnt vmcnt(9)
  s_barrier
  ds_read_b128 v[32:35], v246 offset:16384
  ds_read_b64_tr_b16 v[48:49], v249 offset:8192
  ds_read_b64_tr_b16 v[50:51], v249 offset:9216
  ds_read_b128 v[36:39], v246 offset:17408
  ds_read_b64_tr_b16 v[52:53], v249 offset:10240
  ds_read_b64_tr_b16 v[54:55], v249 offset:11264
  v_readlane_b32 s94, v250, 20
  s_add_u32 m0, s87, 65536
  s_nop 3
  buffer_load_dwordx4 v245, s[16:19], s94 offen lds
  v_readlane_b32 s96, v251, 14
  s_add_u32 m0, s87, 98304
  s_nop 3
  buffer_load_dwordx4 v244, s[24:27], s96 offen sc1 lds
  s_waitcnt lgkmcnt(3)
  v_mfma_f32_32x32x16_bf16 v[16:31], v[48:51], v[32:35], v[16:31]
  s_waitcnt lgkmcnt(0)
  v_mfma_f32_32x32x16_bf16 v[16:31], v[52:55], v[36:39], v[16:31]
  s_waitcnt vmcnt(9)
  s_barrier
  ds_read_b128 v[32:35], v246 offset:24576
  ds_read_b64_tr_b16 v[48:49], v249 offset:16384
  ds_read_b64_tr_b16 v[50:51], v249 offset:17408
  ds_read_b128 v[36:39], v246 offset:25600
  ds_read_b64_tr_b16 v[52:53], v249 offset:18432
  ds_read_b64_tr_b16 v[54:55], v249 offset:19456
  v_readlane_b32 s95, v250, 21
  s_add_u32 m0, s87, 73728
  s_nop 3
  buffer_load_dwordx4 v245, s[16:19], s95 offen lds
  s_waitcnt vmcnt(4)
  v_cmp_ne_u32 vcc, s48, v113
  s_nop 0
  s_cmp_eq_u64 vcc, 0
  s_nop 1
  s_cbranch_scc1 L_apok_21
  s_lshr_b32 s51, s46, 1
  s_lshl_b32 s51, s51, 7
  s_add_u32 s51, s51, 13893632
  v_and_b32 v3, 14, v0
  v_lshlrev_b32 v3, 3, v3
  v_and_b32 v2, 1, v0
  v_lshl_add_u32 v3, v2, 2, v3
  s_mov_b32 s88, 0x40000
L_app_22:
  buffer_load_dword v113, v3, s[24:27], s51 offen sc1
  s_waitcnt vmcnt(0)
  v_cmp_ne_u32 vcc, s48, v113
  s_sub_u32 s88, s88, 1
  s_cmp_eq_u32 s88, 0
  s_nop 1
  s_cbranch_scc1 L_apok_21
  s_cmp_eq_u64 vcc, 0
  s_cbranch_scc0 L_app_22
L_apok_21:
  s_lshl_b32 s51, s46, 1
  s_and_b32 s52, s3, 1
  s_add_u32 s51, s51, s52
  s_lshl_b32 s51, s51, 7
  s_add_u32 s51, s51, 14155776
  v_and_b32 v2, 31, v0
  v_lshlrev_b32 v2, 2, v2
  buffer_load_dword v112, v2, s[24:27], s51 offen sc1
  v_readlane_b32 s97, v251, 15
  s_add_u32 m0, s87, 106496
  s_nop 3
  buffer_load_dwordx4 v244, s[24:27], s97 offen sc1 lds
  s_waitcnt lgkmcnt(3)
  v_mfma_f32_32x32x16_bf16 v[16:31], v[48:51], v[32:35], v[16:31]
  s_waitcnt lgkmcnt(0)
  v_mfma_f32_32x32x16_bf16 v[16:31], v[52:55], v[36:39], v[16:31]
  s_waitcnt vmcnt(10)
  s_barrier
  ds_read_b128 v[32:35], v246 offset:32768
  ds_read_b64_tr_b16 v[48:49], v249 offset:24576
  ds_read_b64_tr_b16 v[50:51], v249 offset:25600
  ds_read_b128 v[36:39], v246 offset:33792
  ds_read_b64_tr_b16 v[52:53], v249 offset:26624
  ds_read_b64_tr_b16 v[54:55], v249 offset:27648
  v_readlane_b32 s94, v250, 22
  s_add_u32 m0, s87, 81920
  s_nop 3
  buffer_load_dwordx4 v245, s[16:19], s94 offen lds
  v_readlane_b32 s96, v251, 16
  s_add_u32 m0, s87, 114688
  s_nop 3
  buffer_load_dwordx4 v244, s[24:27], s96 offen sc1 lds
  s_waitcnt lgkmcnt(3)
  v_mfma_f32_32x32x16_bf16 v[16:31], v[48:51], v[32:35], v[16:31]
  s_waitcnt lgkmcnt(0)
  v_mfma_f32_32x32x16_bf16 v[16:31], v[52:55], v[36:39], v[16:31]
  s_waitcnt vmcnt(10)
  s_barrier
  ds_read_b128 v[32:35], v246 offset:40960
  ds_read_b64_tr_b16 v[48:49], v247 offset:0
  ds_read_b64_tr_b16 v[50:51], v247 offset:1024
  ds_read_b128 v[36:39], v246 offset:41984
  ds_read_b64_tr_b16 v[52:53], v247 offset:2048
  ds_read_b64_tr_b16 v[54:55], v247 offset:3072
  v_readlane_b32 s95, v250, 23
  s_add_u32 m0, s87, 90112
  s_nop 3
  buffer_load_dwordx4 v245, s[16:19], s95 offen lds
  v_readlane_b32 s97, v251, 17
  s_add_u32 m0, s87, 122880
  s_nop 3
  buffer_load_dwordx4 v244, s[24:27], s97 offen sc1 lds
  s_waitcnt lgkmcnt(3)
  v_mfma_f32_32x32x16_bf16 v[16:31], v[48:51], v[32:35], v[16:31]
  s_waitcnt lgkmcnt(0)
  v_mfma_f32_32x32x16_bf16 v[16:31], v[52:55], v[36:39], v[16:31]
  s_waitcnt vmcnt(9)
  s_barrier
  ds_read_b128 v[32:35], v246 offset:49152
  ds_read_b64_tr_b16 v[48:49], v247 offset:8192
  ds_read_b64_tr_b16 v[50:51], v247 offset:9216
  ds_read_b128 v[36:39], v246 offset:50176
  ds_read_b64_tr_b16 v[52:53], v247 offset:10240
  ds_read_b64_tr_b16 v[54:55], v247 offset:11264
  v_readlane_b32 s94, v250, 24
  s_add_u32 m0, s87, 0
  s_nop 3
  buffer_load_dwordx4 v245, s[16:19], s94 offen lds
  v_readlane_b32 s96, v251, 18
  s_add_u32 m0, s87, 131072
  s_nop 3
  buffer_load_dwordx4 v244, s[24:27], s96 offen sc1 lds
  s_waitcnt lgkmcnt(3)
  v_mfma_f32_32x32x16_bf16 v[16:31], v[48:51], v[32:35], v[16:31]
  s_waitcnt lgkmcnt(0)
  v_mfma_f32_32x32x16_bf16 v[16:31], v[52:55], v[36:39], v[16:31]
  s_waitcnt vmcnt(9)
  s_barrier
  ds_read_b128 v[32:35], v246 offset:0
  ds_read_b64_tr_b16 v[48:49], v247 offset:16384
  ds_read_b64_tr_b16 v[50:51], v247 offset:17408
  ds_read_b128 v[36:39], v246 offset:1024
  ds_read_b64_tr_b16 v[52:53], v247 offset:18432
  ds_read_b64_tr_b16 v[54:55], v247 offset:19456
  v_readlane_b32 s95, v250, 25
  s_add_u32 m0, s87, 8192
  s_nop 3
  buffer_load_dwordx4 v245, s[16:19], s95 offen lds
  v_readlane_b32 s97, v251, 19
  s_add_u32 m0, s87, 139264
  s_nop 3
  buffer_load_dwordx4 v244, s[24:27], s97 offen sc1 lds
  s_waitcnt lgkmcnt(3)
  v_mfma_f32_32x32x16_bf16 v[16:31], v[48:51], v[32:35], v[16:31]
  s_waitcnt lgkmcnt(0)
  v_mfma_f32_32x32x16_bf16 v[16:31], v[52:55], v[36:39], v[16:31]
  s_waitcnt vmcnt(8)
  s_barrier
  ds_read_b128 v[32:35], v246 offset:8192
  ds_read_b64_tr_b16 v[48:49], v247 offset:24576
  ds_read_b64_tr_b16 v[50:51], v247 offset:25600
  ds_read_b128 v[36:39], v246 offset:9216
  ds_read_b64_tr_b16 v[52:53], v247 offset:26624
  ds_read_b64_tr_b16 v[54:55], v247 offset:27648
  v_readlane_b32 s94, v250, 26
  s_add_u32 m0, s87, 16384
  s_nop 3
  buffer_load_dwordx4 v245, s[16:19], s94 offen lds
  v_readlane_b32 s96, v251, 20
  s_add_u32 m0, s87, 147456
  s_nop 3
  buffer_load_dwordx4 v244, s[24:27], s96 offen sc1 lds
  s_waitcnt lgkmcnt(3)
  v_mfma_f32_32x32x16_bf16 v[16:31], v[48:51], v[32:35], v[16:31]
  s_waitcnt lgkmcnt(0)
  v_mfma_f32_32x32x16_bf16 v[16:31], v[52:55], v[36:39], v[16:31]
  s_waitcnt vmcnt(8)
  s_barrier
  ds_read_b128 v[32:35], v246 offset:16384
  ds_read_b64_tr_b16 v[48:49], v247 offset:32768
  ds_read_b64_tr_b16 v[50:51], v247 offset:33792
  ds_read_b128 v[36:39], v246 offset:17408
  ds_read_b64_tr_b16 v[52:53], v247 offset:34816
  ds_read_b64_tr_b16 v[54:55], v247 offset:35840
  v_readlane_b32 s95, v250, 27
  s_add_u32 m0, s87, 24576
  s_nop 3
  buffer_load_dwordx4 v245, s[16:19], s95 offen lds
  v_readlane_b32 s97, v251, 21
  s_add_u32 m0, s87, 98304
  s_nop 3
  buffer_load_dwordx4 v244, s[24:27], s97 offen sc1 lds
  s_waitcnt lgkmcnt(3)
  v_mfma_f32_32x32x16_bf16 v[16:31], v[48:51], v[32:35], v[16:31]
  s_waitcnt lgkmcnt(0)
  v_mfma_f32_32x32x16_bf16 v[16:31], v[52:55], v[36:39], v[16:31]
  s_waitcnt vmcnt(8)
  s_barrier
  ds_read_b128 v[32:35], v246 offset:24576
  ds_read_b64_tr_b16 v[48:49], v247 offset:40960
  ds_read_b64_tr_b16 v[50:51], v247 offset:41984
  ds_read_b128 v[36:39], v246 offset:25600
  ds_read_b64_tr_b16 v[52:53], v247 offset:43008
  ds_read_b64_tr_b16 v[54:55], v247 offset:44032
  s_add_u32 m0, s87, 32768
  s_add_u32 s50, s86, 0
  buffer_load_dwordx4 v245, s[20:23], s50 offen lds
  v_readlane_b32 s96, v251, 22
  s_add_u32 m0, s87, 106496
  s_nop 3
  buffer_load_dwordx4 v244, s[24:27], s96 offen sc1 lds
  s_waitcnt lgkmcnt(3)
  v_mfma_f32_32x32x16_bf16 v[16:31], v[48:51], v[32:35], v[16:31]
  s_waitcnt lgkmcnt(0)
  v_mfma_f32_32x32x16_bf16 v[16:31], v[52:55], v[36:39], v[16:31]
  s_waitcnt vmcnt(8)
  s_barrier
  ds_read_b128 v[32:35], v246 offset:32768
  ds_read_b64_tr_b16 v[48:49], v247 offset:49152
  ds_read_b64_tr_b16 v[50:51], v247 offset:50176
  ds_read_b128 v[36:39], v246 offset:33792
  ds_read_b64_tr_b16 v[52:53], v247 offset:51200
  ds_read_b64_tr_b16 v[54:55], v247 offset:52224
  s_add_u32 m0, s87, 40960
  s_add_u32 s50, s86, 50176
  buffer_load_dwordx4 v245, s[20:23], s50 offen lds
  v_readlane_b32 s97, v251, 23
  s_add_u32 m0, s87, 114688
  s_nop 3
  buffer_load_dwordx4 v244, s[24:27], s97 offen sc1 lds
  s_waitcnt lgkmcnt(3)
  v_mfma_f32_32x32x16_bf16 v[16:31], v[48:51], v[32:35], v[16:31]
  s_waitcnt lgkmcnt(0)
  v_mfma_f32_32x32x16_bf16 v[16:31], v[52:55], v[36:39], v[16:31]
  s_waitcnt vmcnt(8)
  s_barrier
  ds_read_b128 v[32:35], v246 offset:40960
  ds_read_b64_tr_b16 v[48:49], v247 offset:57344
  ds_read_b64_tr_b16 v[50:51], v247 offset:58368
  ds_read_b128 v[36:39], v246 offset:41984
  ds_read_b64_tr_b16 v[52:53], v247 offset:59392
  ds_read_b64_tr_b16 v[54:55], v247 offset:60416
  s_add_u32 m0, s87, 49152
  s_add_u32 s50, s86, 100352
  buffer_load_dwordx4 v245, s[20:23], s50 offen lds
  v_readlane_b32 s96, v251, 24
  s_add_u32 m0, s87, 122880
  s_nop 3
  buffer_load_dwordx4 v244, s[24:27], s96 offen sc1 lds
  s_waitcnt lgkmcnt(3)
  v_mfma_f32_32x32x16_bf16 v[16:31], v[48:51], v[32:35], v[16:31]
  s_waitcnt lgkmcnt(0)
  v_mfma_f32_32x32x16_bf16 v[16:31], v[52:55], v[36:39], v[16:31]
  s_waitcnt vmcnt(8)
  s_barrier
  ds_read_b128 v[32:35], v246 offset:49152
  ds_read_b64_tr_b16 v[48:49], v249 offset:0
  ds_read_b64_tr_b16 v[50:51], v249 offset:1024
  ds_read_b128 v[36:39], v246 offset:50176
  ds_read_b64_tr_b16 v[52:53], v249 offset:2048
  ds_read_b64_tr_b16 v[54:55], v249 offset:3072
  s_add_u32 m0, s87, 57344
  s_add_u32 s50, s86, 150528
  buffer_load_dwordx4 v245, s[20:23], s50 offen lds
  v_readlane_b32 s97, v251, 25
  s_add_u32 m0, s87, 131072
  s_nop 3
  buffer_load_dwordx4 v244, s[24:27], s97 offen sc1 lds
  s_waitcnt lgkmcnt(3)
  v_mfma_f32_32x32x16_bf16 v[16:31], v[48:51], v[32:35], v[16:31]
  s_waitcnt lgkmcnt(0)
  v_mfma_f32_32x32x16_bf16 v[16:31], v[52:55], v[36:39], v[16:31]
  s_waitcnt vmcnt(8)
  s_barrier
  ds_read_b128 v[32:35], v246 offset:0
  ds_read_b64_tr_b16 v[48:49], v249 offset:8192
  ds_read_b64_tr_b16 v[50:51], v249 offset:9216
  ds_read_b128 v[36:39], v246 offset:1024
  ds_read_b64_tr_b16 v[52:53], v249 offset:10240
  ds_read_b64_tr_b16 v[54:55], v249 offset:11264
  s_add_u32 m0, s87, 65536
  s_add_u32 s50, s86, 200704
  buffer_load_dwordx4 v245, s[20:23], s50 offen lds
  v_readlane_b32 s96, v251, 26
  s_add_u32 m0, s87, 139264
  s_nop 3
  buffer_load_dwordx4 v244, s[24:27], s96 offen sc1 lds
  s_waitcnt lgkmcnt(3)
  v_mfma_f32_32x32x16_bf16 v[16:31], v[48:51], v[32:35], v[16:31]
  s_waitcnt lgkmcnt(0)
  v_mfma_f32_32x32x16_bf16 v[16:31], v[52:55], v[36:39], v[16:31]
  s_waitcnt vmcnt(8)
  s_barrier
  ds_read_b128 v[32:35], v246 offset:8192
  ds_read_b64_tr_b16 v[48:49], v249 offset:16384
  ds_read_b64_tr_b16 v[50:51], v249 offset:17408
  ds_read_b128 v[36:39], v246 offset:9216
  ds_read_b64_tr_b16 v[52:53], v249 offset:18432
  ds_read_b64_tr_b16 v[54:55], v249 offset:19456
  s_add_u32 m0, s87, 73728
  s_add_u32 s50, s86, 250880
  buffer_load_dwordx4 v245, s[20:23], s50 offen lds
  s_lshr_b32 s51, s46, 1
  s_lshl_b32 s51, s51, 7
  s_add_u32 s51, s51, 13634560
  v_and_b32 v3, 7, v0
  v_lshlrev_b32 v3, 2, v3
  buffer_load_dword v113, v3, s[24:27], s51 offen sc1
  v_readlane_b32 s97, v251, 27
  s_add_u32 m0, s87, 147456
  s_nop 3
  buffer_load_dwordx4 v244, s[24:27], s97 offen sc1 lds
  s_waitcnt lgkmcnt(3)
  v_mfma_f32_32x32x16_bf16 v[16:31], v[48:51], v[32:35], v[16:31]
  s_waitcnt lgkmcnt(0)
  v_mfma_f32_32x32x16_bf16 v[16:31], v[52:55], v[36:39], v[16:31]
  s_waitcnt vmcnt(9)
  s_barrier
  ds_read_b128 v[32:35], v246 offset:16384
  ds_read_b64_tr_b16 v[48:49], v249 offset:24576
  ds_read_b64_tr_b16 v[50:51], v249 offset:25600
  ds_read_b128 v[36:39], v246 offset:17408
  ds_read_b64_tr_b16 v[52:53], v249 offset:26624
  ds_read_b64_tr_b16 v[54:55], v249 offset:27648
  s_add_u32 m0, s87, 81920
  s_add_u32 s50, s86, 301056
  buffer_load_dwordx4 v245, s[20:23], s50 offen lds
  s_waitcnt lgkmcnt(3)
  v_mfma_f32_32x32x16_bf16 v[16:31], v[48:51], v[32:35], v[16:31]
  s_waitcnt lgkmcnt(0)
  v_mfma_f32_32x32x16_bf16 v[16:31], v[52:55], v[36:39], v[16:31]
  s_waitcnt vmcnt(8)
  s_barrier
  ds_read_b128 v[32:35], v246 offset:24576
  ds_read_b64_tr_b16 v[48:49], v247 offset:0
  ds_read_b64_tr_b16 v[50:51], v247 offset:1024
  ds_read_b128 v[36:39], v246 offset:25600
  ds_read_b64_tr_b16 v[52:53], v247 offset:2048
  ds_read_b64_tr_b16 v[54:55], v247 offset:3072
  s_add_u32 m0, s87, 90112
  s_add_u32 s50, s86, 351232
  buffer_load_dwordx4 v245, s[20:23], s50 offen lds
  s_waitcnt vmcnt(3)
  v_cmp_ne_u32 vcc, s48, v113
  s_nop 0
  s_cmp_eq_u64 vcc, 0
  s_nop 1
  s_cbranch_scc1 L_apok_23
  s_lshr_b32 s51, s46, 1
  s_lshl_b32 s51, s51, 7
  s_add_u32 s51, s51, 13634560
  v_and_b32 v3, 7, v0
  v_lshlrev_b32 v3, 2, v3
  s_mov_b32 s88, 0x40000
L_app_24:
  buffer_load_dword v113, v3, s[24:27], s51 offen sc1
  s_waitcnt vmcnt(0)
  v_cmp_ne_u32 vcc, s48, v113
  s_sub_u32 s88, s88, 1
  s_cmp_eq_u32 s88, 0
  s_nop 1
  s_cbranch_scc1 L_apok_23
  s_cmp_eq_u64 vcc, 0
  s_cbranch_scc0 L_app_24
L_apok_23:
  s_add_u32 m0, s87, 98304
  s_add_u32 s50, s84, 114688
  buffer_load_dwordx4 v244, s[24:27], s50 offen sc1 lds
  s_add_u32 m0, s87, 106496
  s_add_u32 s50, s84, 118784
  buffer_load_dwordx4 v244, s[24:27], s50 offen sc1 lds
  s_waitcnt lgkmcnt(3)
  v_mfma_f32_32x32x16_bf16 v[16:31], v[48:51], v[32:35], v[16:31]
  s_waitcnt lgkmcnt(0)
  v_mfma_f32_32x32x16_bf16 v[16:31], v[52:55], v[36:39], v[16:31]
  s_waitcnt vmcnt(9)
  s_barrier
  ds_read_b128 v[32:35], v246 offset:32768
  ds_read_b64_tr_b16 v[48:49], v247 offset:8192
  ds_read_b64_tr_b16 v[50:51], v247 offset:9216
  ds_read_b128 v[36:39], v246 offset:33792
  ds_read_b64_tr_b16 v[52:53], v247 offset:10240
  ds_read_b64_tr_b16 v[54:55], v247 offset:11264
  s_add_u32 m0, s87, 114688
  s_add_u32 s50, s84, 122880
  buffer_load_dwordx4 v244, s[24:27], s50 offen sc1 lds
  s_waitcnt lgkmcnt(3)
  v_mfma_f32_32x32x16_bf16 v[16:31], v[48:51], v[32:35], v[16:31]
  s_waitcnt lgkmcnt(0)
  v_mfma_f32_32x32x16_bf16 v[16:31], v[52:55], v[36:39], v[16:31]
  s_waitcnt vmcnt(8)
  s_barrier
  ds_read_b128 v[32:35], v246 offset:40960
  ds_read_b64_tr_b16 v[48:49], v247 offset:16384
  ds_read_b64_tr_b16 v[50:51], v247 offset:17408
  ds_read_b128 v[36:39], v246 offset:41984
  ds_read_b64_tr_b16 v[52:53], v247 offset:18432
  ds_read_b64_tr_b16 v[54:55], v247 offset:19456
  s_add_u32 m0, s87, 122880
  s_add_u32 s50, s84, 126976
  buffer_load_dwordx4 v244, s[24:27], s50 offen sc1 lds
  s_waitcnt lgkmcnt(3)
  v_mfma_f32_32x32x16_bf16 v[16:31], v[48:51], v[32:35], v[16:31]
  s_waitcnt lgkmcnt(0)
  v_mfma_f32_32x32x16_bf16 v[16:31], v[52:55], v[36:39], v[16:31]
  s_waitcnt vmcnt(6)
  s_barrier
  ds_read_b128 v[32:35], v246 offset:49152
  ds_read_b64_tr_b16 v[48:49], v247 offset:24576
  ds_read_b64_tr_b16 v[50:51], v247 offset:25600
  ds_read_b128 v[36:39], v246 offset:50176
  ds_read_b64_tr_b16 v[52:53], v247 offset:26624
  ds_read_b64_tr_b16 v[54:55], v247 offset:27648
  s_add_u32 m0, s87, 131072
  s_add_u32 s50, s84, 131072
  buffer_load_dwordx4 v244, s[24:27], s50 offen sc1 lds
  s_waitcnt lgkmcnt(3)
  v_mfma_f32_32x32x16_bf16 v[16:31], v[48:51], v[32:35], v[16:31]
  s_waitcnt lgkmcnt(0)
  v_mfma_f32_32x32x16_bf16 v[16:31], v[52:55], v[36:39], v[16:31]
  s_waitcnt vmcnt(4)
  s_barrier
  ds_read_b128 v[32:35], v246 offset:0
  ds_read_b64_tr_b16 v[48:49], v247 offset:32768
  ds_read_b64_tr_b16 v[50:51], v247 offset:33792
  ds_read_b128 v[36:39], v246 offset:1024
  ds_read_b64_tr_b16 v[52:53], v247 offset:34816
  ds_read_b64_tr_b16 v[54:55], v247 offset:35840
  s_add_u32 m0, s87, 139264
  s_add_u32 s50, s84, 135168
  buffer_load_dwordx4 v244, s[24:27], s50 offen sc1 lds
  s_waitcnt lgkmcnt(3)
  v_mfma_f32_32x32x16_bf16 v[96:111], v[48:51], v[32:35], 0
  s_waitcnt lgkmcnt(0)
  v_mfma_f32_32x32x16_bf16 v[96:111], v[52:55], v[36:39], v[96:111]
  s_waitcnt vmcnt(4)
  s_barrier
  ds_read_b128 v[32:35], v246 offset:8192
  ds_read_b64_tr_b16 v[48:49], v247 offset:40960
  ds_read_b64_tr_b16 v[50:51], v247 offset:41984
  ds_read_b128 v[36:39], v246 offset:9216
  ds_read_b64_tr_b16 v[52:53], v247 offset:43008
  ds_read_b64_tr_b16 v[54:55], v247 offset:44032
  s_add_u32 m0, s87, 147456
  s_add_u32 s50, s84, 139264
  buffer_load_dwordx4 v244, s[24:27], s50 offen sc1 lds
  s_waitcnt lgkmcnt(3)
  v_mfma_f32_32x32x16_bf16 v[96:111], v[48:51], v[32:35], v[96:111]
  s_waitcnt lgkmcnt(0)
  v_mfma_f32_32x32x16_bf16 v[96:111], v[52:55], v[36:39], v[96:111]
  s_waitcnt vmcnt(4)
  s_barrier
  ds_read_b128 v[32:35], v246 offset:16384
  ds_read_b64_tr_b16 v[48:49], v247 offset:49152
  ds_read_b64_tr_b16 v[50:51], v247 offset:50176
  ds_read_b128 v[36:39], v246 offset:17408
  ds_read_b64_tr_b16 v[52:53], v247 offset:51200
  ds_read_b64_tr_b16 v[54:55], v247 offset:52224
  s_add_u32 m0, s87, 98304
  s_add_u32 s50, s84, 143360
  buffer_load_dwordx4 v244, s[24:27], s50 offen sc1 lds
  s_waitcnt lgkmcnt(3)
  v_mfma_f32_32x32x16_bf16 v[96:111], v[48:51], v[32:35], v[96:111]
  s_waitcnt lgkmcnt(0)
  v_mfma_f32_32x32x16_bf16 v[96:111], v[52:55], v[36:39], v[96:111]
  s_waitcnt vmcnt(4)
  s_barrier
  ds_read_b128 v[32:35], v246 offset:24576
  ds_read_b64_tr_b16 v[48:49], v247 offset:57344
  ds_read_b64_tr_b16 v[50:51], v247 offset:58368
  ds_read_b128 v[36:39], v246 offset:25600
  ds_read_b64_tr_b16 v[52:53], v247 offset:59392
  ds_read_b64_tr_b16 v[54:55], v247 offset:60416
  s_waitcnt lgkmcnt(3)
  v_mfma_f32_32x32x16_bf16 v[96:111], v[48:51], v[32:35], v[96:111]
  s_waitcnt lgkmcnt(0)
  v_mfma_f32_32x32x16_bf16 v[96:111], v[52:55], v[36:39], v[96:111]
  s_waitcnt vmcnt(3)
  s_barrier
  ds_read_b128 v[32:35], v246 offset:32768
  ds_read_b64_tr_b16 v[48:49], v249 offset:0
  ds_read_b64_tr_b16 v[50:51], v249 offset:1024
  ds_read_b128 v[36:39], v246 offset:33792
  ds_read_b64_tr_b16 v[52:53], v249 offset:2048
  ds_read_b64_tr_b16 v[54:55], v249 offset:3072
  s_waitcnt lgkmcnt(3)
  v_mfma_f32_32x32x16_bf16 v[96:111], v[48:51], v[32:35], v[96:111]
  s_waitcnt lgkmcnt(0)
  v_mfma_f32_32x32x16_bf16 v[96:111], v[52:55], v[36:39], v[96:111]
  s_waitcnt vmcnt(2)
  s_barrier
  ds_read_b128 v[32:35], v246 offset:40960
  ds_read_b64_tr_b16 v[48:49], v249 offset:8192
  ds_read_b64_tr_b16 v[50:51], v249 offset:9216
  ds_read_b128 v[36:39], v246 offset:41984
  ds_read_b64_tr_b16 v[52:53], v249 offset:10240
  ds_read_b64_tr_b16 v[54:55], v249 offset:11264
  s_waitcnt lgkmcnt(3)
  v_mfma_f32_32x32x16_bf16 v[96:111], v[48:51], v[32:35], v[96:111]
  s_waitcnt lgkmcnt(0)
  v_mfma_f32_32x32x16_bf16 v[96:111], v[52:55], v[36:39], v[96:111]
  s_waitcnt vmcnt(1)
  s_barrier
  ds_read_b128 v[32:35], v246 offset:49152
  ds_read_b64_tr_b16 v[48:49], v249 offset:16384
  ds_read_b64_tr_b16 v[50:51], v249 offset:17408
  ds_read_b128 v[36:39], v246 offset:50176
  ds_read_b64_tr_b16 v[52:53], v249 offset:18432
  ds_read_b64_tr_b16 v[54:55], v249 offset:19456
  s_waitcnt lgkmcnt(3)
  v_mfma_f32_32x32x16_bf16 v[96:111], v[48:51], v[32:35], v[96:111]
  s_waitcnt lgkmcnt(0)
  v_mfma_f32_32x32x16_bf16 v[96:111], v[52:55], v[36:39], v[96:111]
  s_waitcnt vmcnt(0)
  s_barrier
  ds_read_b128 v[32:35], v246 offset:0
  ds_read_b64_tr_b16 v[48:49], v249 offset:24576
  ds_read_b64_tr_b16 v[50:51], v249 offset:25600
  ds_read_b128 v[36:39], v246 offset:1024
  ds_read_b64_tr_b16 v[52:53], v249 offset:26624
  ds_read_b64_tr_b16 v[54:55], v249 offset:27648
  s_waitcnt lgkmcnt(3)
  v_mfma_f32_32x32x16_bf16 v[96:111], v[48:51], v[32:35], v[96:111]
  s_waitcnt lgkmcnt(0)
  v_mfma_f32_32x32x16_bf16 v[96:111], v[52:55], v[36:39], v[96:111]
  s_waitcnt vmcnt(36)
  s_nop 10
  v_sub_f32 v96, v96, v16
  v_sub_f32 v97, v97, v17
  v_sub_f32 v98, v98, v18
  v_sub_f32 v99, v99, v19
  v_sub_f32 v100, v100, v20
  v_sub_f32 v101, v101, v21
  v_sub_f32 v102, v102, v22
  v_sub_f32 v103, v103, v23
  v_sub_f32 v104, v104, v24
  v_sub_f32 v105, v105, v25
  v_sub_f32 v106, v106, v26
  v_sub_f32 v107, v107, v27
  v_sub_f32 v108, v108, v28
  v_sub_f32 v109, v109, v29
  v_sub_f32 v110, v110, v30
  v_sub_f32 v111, v111, v31
  v_fmac_f32 v16, v112, v96
  v_fmac_f32 v17, v112, v97
  v_fmac_f32 v18, v112, v98
  v_fmac_f32 v19, v112, v99
  v_fmac_f32 v20, v112, v100
  v_fmac_f32 v21, v112, v101
  v_fmac_f32 v22, v112, v102
  v_fmac_f32 v23, v112, v103
  v_fmac_f32 v24, v112, v104
  v_fmac_f32 v25, v112, v105
  v_fmac_f32 v26, v112, v106
  v_fmac_f32 v27, v112, v107
  v_fmac_f32 v28, v112, v108
  v_fmac_f32 v29, v112, v109
  v_fmac_f32 v30, v112, v110
  v_fmac_f32 v31, v112, v111
  s_lshl_b32 s50, s3, 11
  s_add_u32 s50, s50, 0
  v_lshlrev_b32 v1, 4, v0
  v_add_u32 v2, s50, v1
  s_xor_b32 s51, s3, 4
  s_lshl_b32 s51, s51, 11
  s_add_u32 s51, s51, 0
  v_add_u32 v3, s51, v1
  v_and_b32 v4, 31, v0
  s_lshl_b32 s50, s46, 6
  s_and_b32 s51, s3, 1
  s_lshl_b32 s51, s51, 5
  s_add_u32 s50, s50, s51
  v_add_u32 v4, s50, v4
  v_mul_u32_u24 v4, 896, v4
  v_lshrrev_b32 v5, 5, v0
  v_lshl_add_u32 v4, v5, 4, v4
  s_lshl_b32 s50, s47, 7
  s_lshr_b32 s51, s3, 1
  s_and_b32 s51, s51, 1
  s_lshl_b32 s51, s51, 6
  s_add_u32 s50, s50, s51
  s_lshr_b32 s51, s3, 2
  s_lshl_b32 s51, s51, 5
  s_add_u32 s50, s50, s51
  s_cmp_ge_u32 s3, 4
  s_cbranch_scc1 L_kh1_25
  ds_write_b128 v2, v[24:27]
  ds_write_b128 v2, v[28:31] offset:1024
  s_branch L_khj_26
L_kh1_25:
  ds_write_b128 v2, v[16:19]
  ds_write_b128 v2, v[20:23] offset:1024
  v_mov_b32 v16, v24
  v_mov_b32 v17, v25
  v_mov_b32 v18, v26
  v_mov_b32 v19, v27
  v_mov_b32 v20, v28
  v_mov_b32 v21, v29
  v_mov_b32 v22, v30
  v_mov_b32 v23, v31
L_khj_26:
  s_waitcnt lgkmcnt(0)
  s_barrier
  ds_read_b128 v[32:35], v3
  ds_read_b128 v[36:39], v3 offset:1024
  s_waitcnt lgkmcnt(0)
  v_add_f32 v16, v16, v32
  v_add_f32 v17, v17, v33
  v_add_f32 v18, v18, v34
  v_add_f32 v19, v19, v35
  v_add_f32 v20, v20, v36
  v_add_f32 v21, v21, v37
  v_add_f32 v22, v22, v38
  v_add_f32 v23, v23, v39
  v_cvt_pk_bf16_f32 v40, v16, v17
  v_cvt_pk_bf16_f32 v41, v18, v19
  v_cvt_pk_bf16_f32 v42, v20, v21
  v_cvt_pk_bf16_f32 v43, v22, v23
  s_nop 0
  v_permlane32_swap_b32 v40, v42
  v_permlane32_swap_b32 v41, v43
  buffer_store_dwordx4 v[40:43], v4, s[28:31], s50 offen
  s_branch L_fin
L_phase2_att:
  s_cmp_lg_u32 s3, 0
  s_cbranch_scc1 L_g1w_27
  s_lshr_b32 s51, s46, 1
  s_lshl_b32 s51, s51, 7
  s_add_u32 s51, s51, 13631488
  v_and_b32 v3, 14, v0
  v_lshlrev_b32 v3, 3, v3
  v_and_b32 v2, 1, v0
  v_lshl_add_u32 v3, v2, 2, v3
  s_mov_b32 s88, 0x40000
L_spp_29:
  buffer_load_dword v113, v3, s[24:27], s51 offen sc1
  s_waitcnt vmcnt(0)
  v_cmp_ne_u32 vcc, s48, v113
  s_sub_u32 s88, s88, 1
  s_cmp_eq_u32 s88, 0
  s_nop 1
  s_cbranch_scc1 L_spok_28
  s_cmp_eq_u64 vcc, 0
  s_cbranch_scc0 L_spp_29
L_spok_28:
L_g1w_27:
  s_barrier
  v_readlane_b32 s96, v251, 0
  s_add_u32 m0, s87, 98304
  s_nop 3
  buffer_load_dwordx4 v244, s[24:27], s96 offen sc1 lds
  v_readlane_b32 s97, v251, 1
  s_add_u32 m0, s87, 106496
  s_nop 3
  buffer_load_dwordx4 v244, s[24:27], s97 offen sc1 lds
  v_readlane_b32 s96, v251, 2
  s_add_u32 m0, s87, 114688
  s_nop 3
  buffer_load_dwordx4 v244, s[24:27], s96 offen sc1 lds
  v_readlane_b32 s97, v251, 3
  s_add_u32 m0, s87, 122880
  s_nop 3
  buffer_load_dwordx4 v244, s[24:27], s97 offen sc1 lds
  v_readlane_b32 s96, v251, 4
  s_add_u32 m0, s87, 131072
  s_nop 3
  buffer_load_dwordx4 v244, s[24:27], s96 offen sc1 lds
  v_readlane_b32 s97, v251, 5
  s_add_u32 m0, s87, 139264
  s_nop 3
  buffer_load_dwordx4 v244, s[24:27], s97 offen sc1 lds
  v_readlane_b32 s94, v250, 6
  s_add_u32 m0, s87, 49152
  s_nop 3
  buffer_load_dwordx4 v245, s[16:19], s94 offen lds
  v_readlane_b32 s95, v250, 7
  s_add_u32 m0, s87, 57344
  s_nop 3
  buffer_load_dwordx4 v245, s[16:19], s95 offen lds
  v_readlane_b32 s94, v250, 8
  s_add_u32 m0, s87, 65536
  s_nop 3
  buffer_load_dwordx4 v245, s[16:19], s94 offen lds
  v_readlane_b32 s95, v250, 9
  s_add_u32 m0, s87, 73728
  s_nop 3
  buffer_load_dwordx4 v245, s[16:19], s95 offen lds
  v_readlane_b32 s94, v250, 10
  s_add_u32 m0, s87, 81920
  s_nop 3
  buffer_load_dwordx4 v245, s[16:19], s94 offen lds
  v_readlane_b32 s95, v250, 11
  s_add_u32 m0, s87, 90112
  s_nop 3
  buffer_load_dwordx4 v245, s[16:19], s95 offen lds
  s_waitcnt vmcnt(11)
  s_barrier
  ds_read_b128 v[32:35], v246 offset:0
  ds_read_b64_tr_b16 v[48:49], v247 offset:0
  ds_read_b64_tr_b16 v[50:51], v247 offset:1024
  ds_read_b128 v[36:39], v246 offset:1024
  ds_read_b64_tr_b16 v[52:53], v247 offset:2048
  ds_read_b64_tr_b16 v[54:55], v247 offset:3072
  s_waitcnt lgkmcnt(3)
  v_mfma_f32_32x32x16_bf16 v[16:31], v[48:51], v[32:35], 0
  s_waitcnt lgkmcnt(0)
  v_mfma_f32_32x32x16_bf16 v[16:31], v[52:55], v[36:39], v[16:31]
  s_waitcnt vmcnt(10)
  s_barrier
  ds_read_b128 v[32:35], v246 offset:8192
  ds_read_b64_tr_b16 v[48:49], v247 offset:8192
  ds_read_b64_tr_b16 v[50:51], v247 offset:9216
  ds_read_b128 v[36:39], v246 offset:9216
  ds_read_b64_tr_b16 v[52:53], v247 offset:10240
  ds_read_b64_tr_b16 v[54:55], v247 offset:11264
  v_readlane_b32 s94, v250, 12
  s_add_u32 m0, s87, 0
  s_nop 3
  buffer_load_dwordx4 v245, s[16:19], s94 offen lds
  v_readlane_b32 s96, v251, 6
  s_add_u32 m0, s87, 147456
  s_nop 3
  buffer_load_dwordx4 v244, s[24:27], s96 offen sc1 lds
  s_waitcnt lgkmcnt(3)
  v_mfma_f32_32x32x16_bf16 v[16:31], v[48:51], v[32:35], v[16:31]
  s_waitcnt lgkmcnt(0)
  v_mfma_f32_32x32x16_bf16 v[16:31], v[52:55], v[36:39], v[16:31]
  s_waitcnt vmcnt(11)
  s_barrier
  ds_read_b128 v[32:35], v246 offset:16384
  ds_read_b64_tr_b16 v[48:49], v247 offset:16384
  ds_read_b64_tr_b16 v[50:51], v247 offset:17408
  ds_read_b128 v[36:39], v246 offset:17408
  ds_read_b64_tr_b16 v[52:53], v247 offset:18432
  ds_read_b64_tr_b16 v[54:55], v247 offset:19456
  v_readlane_b32 s95, v250, 13
  s_add_u32 m0, s87, 8192
  s_nop 3
  buffer_load_dwordx4 v245, s[16:19], s95 offen lds
  v_readlane_b32 s97, v251, 7
  s_add_u32 m0, s87, 98304
  s_nop 3
  buffer_load_dwordx4 v244, s[24:27], s97 offen sc1 lds
  s_waitcnt lgkmcnt(3)
  v_mfma_f32_32x32x16_bf16 v[16:31], v[48:51], v[32:35], v[16:31]
  s_waitcnt lgkmcnt(0)
  v_mfma_f32_32x32x16_bf16 v[16:31], v[52:55], v[36:39], v[16:31]
  s_waitcnt vmcnt(12)
  s_barrier
  ds_read_b128 v[32:35], v246 offset:24576
  ds_read_b64_tr_b16 v[48:49], v247 offset:24576
  ds_read_b64_tr_b16 v[50:51], v247 offset:25600
  ds_read_b128 v[36:39], v246 offset:25600
  ds_read_b64_tr_b16 v[52:53], v247 offset:26624
  ds_read_b64_tr_b16 v[54:55], v247 offset:27648
  v_readlane_b32 s94, v250, 14
  s_add_u32 m0, s87, 16384
  s_nop 3
  buffer_load_dwordx4 v245, s[16:19], s94 offen lds
  v_readlane_b32 s96, v251, 8
  s_add_u32 m0, s87, 106496
  s_nop 3
  buffer_load_dwordx4 v244, s[24:27], s96 offen sc1 lds
  s_waitcnt lgkmcnt(3)
  v_mfma_f32_32x32x16_bf16 v[16:31], v[48:51], v[32:35], v[16:31]
  s_waitcnt lgkmcnt(0)
  v_mfma_f32_32x32x16_bf16 v[16:31], v[52:55], v[36:39], v[16:31]
  s_lshl_b32 s50, s45, 14
  s_and_b32 s51, s3, 4
  s_lshl_b32 s51, s51, 11
  s_add_u32 s50, s50, s51
  s_add_u32 s50, s50, 12582912
  v_lshlrev_b32 v1, 4, v0
  buffer_load_dwordx4 v[60:63], v1, s[24:27], s50 offen offset:0 sc1
  buffer_load_dwordx4 v[64:67], v1, s[24:27], s50 offen offset:1024 sc1
  s_add_u32 s50, s50, 2048
  buffer_load_dwordx4 v[68:71], v1, s[24:27], s50 offen offset:0 sc1
  buffer_load_dwordx4 v[72:75], v1, s[24:27], s50 offen offset:1024 sc1
  s_add_u32 s50, s50, 2048
  buffer_load_dwordx4 v[76:79], v1, s[24:27], s50 offen offset:0 sc1
  buffer_load_dwordx4 v[80:83], v1, s[24:27], s50 offen offset:1024 sc1
  s_add_u32 s50, s50, 2048
  buffer_load_dwordx4 v[84:87], v1, s[24:27], s50 offen offset:0 sc1
  buffer_load_dwordx4 v[88:91], v1, s[24:27], s50 offen offset:1024 sc1
  s_waitcnt vmcnt(21)
  s_barrier
  ds_read_b128 v[32:35], v246 offset:32768
  ds_read_b64_tr_b16 v[48:49], v247 offset:32768
  ds_read_b64_tr_b16 v[50:51], v247 offset:33792
  ds_read_b128 v[36:39], v246 offset:33792
  ds_read_b64_tr_b16 v[52:53], v247 offset:34816
  ds_read_b64_tr_b16 v[54:55], v247 offset:35840
  v_readlane_b32 s95, v250, 15
  s_add_u32 m0, s87, 24576
  s_nop 3
  buffer_load_dwordx4 v245, s[16:19], s95 offen lds
  v_readlane_b32 s97, v251, 9
  s_add_u32 m0, s87, 114688
  s_nop 3
  buffer_load_dwordx4 v244, s[24:27], s97 offen sc1 lds
  s_waitcnt lgkmcnt(3)
  v_mfma_f32_32x32x16_bf16 v[16:31], v[48:51], v[32:35], v[16:31]
  s_waitcnt lgkmcnt(0)
  v_mfma_f32_32x32x16_bf16 v[16:31], v[52:55], v[36:39], v[16:31]
  s_waitcnt vmcnt(22)
  s_barrier
  ds_read_b128 v[32:35], v246 offset:40960
  ds_read_b64_tr_b16 v[48:49], v247 offset:40960
  ds_read_b64_tr_b16 v[50:51], v247 offset:41984
  ds_read_b128 v[36:39], v246 offset:41984
  ds_read_b64_tr_b16 v[52:53], v247 offset:43008
  ds_read_b64_tr_b16 v[54:55], v247 offset:44032
  v_readlane_b32 s94, v250, 16
  s_add_u32 m0, s87, 32768
  s_nop 3
  buffer_load_dwordx4 v245, s[16:19], s94 offen lds
  v_readlane_b32 s96, v251, 10
  s_add_u32 m0, s87, 122880
  s_nop 3
  buffer_load_dwordx4 v244, s[24:27], s96 offen sc1 lds
  s_waitcnt lgkmcnt(3)
  v_mfma_f32_32x32x16_bf16 v[16:31], v[48:51], v[32:35], v[16:31]
  s_waitcnt lgkmcnt(0)
  v_mfma_f32_32x32x16_bf16 v[16:31], v[52:55], v[36:39], v[16:31]
  s_waitcnt vmcnt(16)
  s_barrier
  ds_read_b128 v[32:35], v246 offset:49152
  ds_read_b64_tr_b16 v[48:49], v247 offset:49152
  ds_read_b64_tr_b16 v[50:51], v247 offset:50176
  ds_read_b128 v[36:39], v246 offset:50176
  ds_read_b64_tr_b16 v[52:53], v247 offset:51200
  ds_read_b64_tr_b16 v[54:55], v247 offset:52224
  v_readlane_b32 s95, v250, 17
  s_add_u32 m0, s87, 40960
  s_nop 3
  buffer_load_dwordx4 v245, s[16:19], s95 offen lds
  v_readlane_b32 s97, v251, 11
  s_add_u32 m0, s87, 131072
  s_nop 3
  buffer_load_dwordx4 v244, s[24:27], s97 offen sc1 lds
  s_waitcnt lgkmcnt(3)
  v_mfma_f32_32x32x16_bf16 v[16:31], v[48:51], v[32:35], v[16:31]
  s_waitcnt lgkmcnt(0)
  v_mfma_f32_32x32x16_bf16 v[16:31], v[52:55], v[36:39], v[16:31]
  s_waitcnt vmcnt(16)
  s_barrier
  ds_read_b128 v[32:35], v246 offset:0
  ds_read_b64_tr_b16 v[48:49], v247 offset:57344
  ds_read_b64_tr_b16 v[50:51], v247 offset:58368
  ds_read_b128 v[36:39], v246 offset:1024
  ds_read_b64_tr_b16 v[52:53], v247 offset:59392
  ds_read_b64_tr_b16 v[54:55], v247 offset:60416
  v_readlane_b32 s94, v250, 18
  s_add_u32 m0, s87, 49152
  s_nop 3
  buffer_load_dwordx4 v245, s[16:19], s94 offen lds
  v_readlane_b32 s96, v251, 12
  s_add_u32 m0, s87, 139264
  s_nop 3
  buffer_load_dwordx4 v244, s[24:27], s96 offen sc1 lds
  s_waitcnt lgkmcnt(3)
  v_mfma_f32_32x32x16_bf16 v[16:31], v[48:51], v[32:35], v[16:31]
  s_waitcnt lgkmcnt(0)
  v_mfma_f32_32x32x16_bf16 v[16:31], v[52:55], v[36:39], v[16:31]
  s_waitcnt vmcnt(16)
  s_barrier
  ds_read_b128 v[32:35], v246 offset:8192
  ds_read_b64_tr_b16 v[48:49], v249 offset:0
  ds_read_b64_tr_b16 v[50:51], v249 offset:1024
  ds_read_b128 v[36:39], v246 offset:9216
  ds_read_b64_tr_b16 v[52:53], v249 offset:2048
  ds_read_b64_tr_b16 v[54:55], v249 offset:3072
  v_readlane_b32 s95, v250, 19
  s_add_u32 m0, s87, 57344
  s_nop 3
  buffer_load_dwordx4 v245, s[16:19], s95 offen lds
  s_lshr_b32 s51, s46, 1
  s_lshl_b32 s51, s51, 7
  s_add_u32 s51, s51, 13893632
  v_and_b32 v3, 14, v0
  v_lshlrev_b32 v3, 3, v3
  v_and_b32 v2, 1, v0
  v_lshl_add_u32 v3, v2, 2, v3
  buffer_load_dword v113, v3, s[24:27], s51 offen sc1
  v_readlane_b32 s97, v251, 13
  s_add_u32 m0, s87, 147456
  s_nop 3
  buffer_load_dwordx4 v244, s[24:27], s97 offen sc1 lds
  s_waitcnt lgkmcnt(3)
  v_mfma_f32_32x32x16_bf16 v[16:31], v[48:51], v[32:35], v[16:31]
  s_waitcnt lgkmcnt(0)
  v_mfma_f32_32x32x16_bf16 v[16:31], v[52:55], v[36:39], v[16:31]
  s_waitcnt vmcnt(11)
  s_mov_b32 s88, 0x40000
L_fre_31:
  v_mov_b32 v2, 0
  v_perm_b32 v3, v61, v60, s4
  v_perm_b32 v4, v63, v62, s5
  v_add3_u32 v3, v3, v4, s79
  v_or_b32 v2, v2, v3
  v_perm_b32 v3, v65, v64, s4
  v_perm_b32 v4, v67, v66, s5
  v_add3_u32 v3, v3, v4, s79
  v_or_b32 v2, v2, v3
  v_perm_b32 v3, v69, v68, s4
  v_perm_b32 v4, v71, v70, s5
  v_add3_u32 v3, v3, v4, s79
  v_or_b32 v2, v2, v3
  v_perm_b32 v3, v73, v72, s4
  v_perm_b32 v4, v75, v74, s5
  v_add3_u32 v3, v3, v4, s79
  v_or_b32 v2, v2, v3
  v_perm_b32 v3, v77, v76, s4
  v_perm_b32 v4, v79, v78, s5
  v_add3_u32 v3, v3, v4, s79
  v_or_b32 v2, v2, v3
  v_perm_b32 v3, v81, v80, s4
  v_perm_b32 v4, v83, v82, s5
  v_add3_u32 v3, v3, v4, s79
  v_or_b32 v2, v2, v3
  v_perm_b32 v3, v85, v84, s4
  v_perm_b32 v4, v87, v86, s5
  v_add3_u32 v3, v3, v4, s79
  v_or_b32 v2, v2, v3
  v_perm_b32 v3, v89, v88, s4
  v_perm_b32 v4, v91, v90, s5
  v_add3_u32 v3, v3, v4, s79
  v_or_b32 v2, v2, v3
  v_cmp_ne_u32 vcc, 0, v2
  s_nop 0
  s_cmp_eq_u64 vcc, 0
  s_nop 1
  s_cbranch_scc1 L_fok_30
  s_sub_u32 s88, s88, 1
  s_cmp_eq_u32 s88, 0
  s_cbranch_scc1 L_fok_30
  s_lshl_b32 s50, s45, 14
  s_and_b32 s51, s3, 4
  s_lshl_b32 s51, s51, 11
  s_add_u32 s50, s50, s51
  s_add_u32 s50, s50, 12582912
  v_lshlrev_b32 v1, 4, v0
  buffer_load_dwordx4 v[60:63], v1, s[24:27], s50 offen offset:0 sc1
  buffer_load_dwordx4 v[64:67], v1, s[24:27], s50 offen offset:1024 sc1
  s_add_u32 s50, s50, 2048
  buffer_load_dwordx4 v[68:71], v1, s[24:27], s50 offen offset:0 sc1
  buffer_load_dwordx4 v[72:75], v1, s[24:27], s50 offen offset:1024 sc1
  s_add_u32 s50, s50, 2048
  buffer_load_dwordx4 v[76:79], v1, s[24:27], s50 offen offset:0 sc1
  buffer_load_dwordx4 v[80:83], v1, s[24:27], s50 offen offset:1024 sc1
  s_add_u32 s50, s50, 2048
  buffer_load_dwordx4 v[84:87], v1, s[24:27], s50 offen offset:0 sc1
  buffer_load_dwordx4 v[88:91], v1, s[24:27], s50 offen offset:1024 sc1
  s_waitcnt vmcnt(0)
  s_branch L_fre_31
L_fok_30:
  v_cvt_pk_bf16_f32 v188, v60, v61
  v_cvt_pk_bf16_f32 v189, v62, v63
  v_cvt_pk_bf16_f32 v190, v64, v65
  v_cvt_pk_bf16_f32 v191, v66, v67
  v_cvt_pk_bf16_f32 v192, v68, v69
  v_cvt_pk_bf16_f32 v193, v70, v71
  v_cvt_pk_bf16_f32 v194, v72, v73
  v_cvt_pk_bf16_f32 v195, v74, v75
  v_cvt_pk_bf16_f32 v196, v76, v77
  v_cvt_pk_bf16_f32 v197, v78, v79
  v_cvt_pk_bf16_f32 v198, v80, v81
  v_cvt_pk_bf16_f32 v199, v82, v83
  v_cvt_pk_bf16_f32 v200, v84, v85
  v_cvt_pk_bf16_f32 v201, v86, v87
  v_cvt_pk_bf16_f32 v202, v88, v89
  v_cvt_pk_bf16_f32 v203, v90, v91
  v_mfma_f32_32x32x16_bf16 v[156:171], v[188:191], v[172:175], 0
  v_mfma_f32_32x32x16_bf16 v[156:171], v[192:195], v[176:179], v[156:171]
  v_mfma_f32_32x32x16_bf16 v[156:171], v[196:199], v[180:183], v[156:171]
  v_mfma_f32_32x32x16_bf16 v[156:171], v[200:203], v[184:187], v[156:171]
  s_lshl_b32 s50, s44, 2
  s_and_b32 s51, s3, 3
  s_add_u32 s50, s50, s51
  s_mul_i32 s50, s50, 144
  s_lshl_b32 s51, s45, 2
  s_add_u32 s50, s50, s51
  s_lshr_b32 s51, s3, 2
  s_lshl_b32 s51, s51, 1
  s_add_u32 s50, s50, s51
  s_add_u32 s50, s50, 112
  s_lshl_b32 s50, s50, 10
  s_nop 0
  v_mov_b32 v3, v168
  v_mov_b32 v4, v168
  s_nop 1
  v_permlane32_swap_b32 v3, v4
  v_add_f32 v4, 0x358637bd, v4
  v_rcp_f32 v4, v4
  s_nop 0
  v_mul_f32 v156, v156, v4
  v_mul_f32 v157, v157, v4
  v_mul_f32 v158, v158, v4
  v_mul_f32 v159, v159, v4
  v_mul_f32 v160, v160, v4
  v_mul_f32 v161, v161, v4
  v_mul_f32 v162, v162, v4
  v_mul_f32 v163, v163, v4
  v_mul_f32 v164, v164, v4
  v_mul_f32 v165, v165, v4
  v_mul_f32 v166, v166, v4
  v_mul_f32 v167, v167, v4
  v_mul_f32 v168, v168, v4
  v_mul_f32 v169, v169, v4
  v_mul_f32 v170, v170, v4
  v_mul_f32 v171, v171, v4
  v_cndmask_b32 v168, v168, 0, s[60:61]
  v_cndmask_b32 v169, v169, 0, s[60:61]
  v_cndmask_b32 v170, v170, 0, s[60:61]
  v_cndmask_b32 v171, v171, 0, s[60:61]
  v_cvt_pk_bf16_f32 v204, v156, v157
  v_cvt_pk_bf16_f32 v205, v158, v159
  v_cvt_pk_bf16_f32 v206, v160, v161
  v_cvt_pk_bf16_f32 v207, v162, v163
  v_cvt_pk_bf16_f32 v208, v164, v165
  v_cvt_pk_bf16_f32 v209, v166, v167
  v_cvt_pk_bf16_f32 v210, v168, v169
  v_cvt_pk_bf16_f32 v211, v170, v171
  v_lshlrev_b32 v1, 4, v0
  buffer_store_dwordx4 v[204:207], v1, s[24:27], s50 offen sc1
  buffer_store_dwordx4 v[208:211], v1, s[24:27], s50 offen offset:1024 sc1
  s_waitcnt vmcnt(11)
  s_barrier
  ds_read_b128 v[32:35], v246 offset:16384
  ds_read_b64_tr_b16 v[48:49], v249 offset:8192
  ds_read_b64_tr_b16 v[50:51], v249 offset:9216
  ds_read_b128 v[36:39], v246 offset:17408
  ds_read_b64_tr_b16 v[52:53], v249 offset:10240
  ds_read_b64_tr_b16 v[54:55], v249 offset:11264
  v_readlane_b32 s94, v250, 20
  s_add_u32 m0, s87, 65536
  s_nop 3
  buffer_load_dwordx4 v245, s[16:19], s94 offen lds
  v_readlane_b32 s96, v251, 14
  s_add_u32 m0, s87, 98304
  s_nop 3
  buffer_load_dwordx4 v244, s[24:27], s96 offen sc1 lds
  s_waitcnt lgkmcnt(3)
  v_mfma_f32_32x32x16_bf16 v[16:31], v[48:51], v[32:35], v[16:31]
  s_waitcnt lgkmcnt(0)
  v_mfma_f32_32x32x16_bf16 v[16:31], v[52:55], v[36:39], v[16:31]
  s_waitcnt vmcnt(11)
  s_barrier
  ds_read_b128 v[32:35], v246 offset:24576
  ds_read_b64_tr_b16 v[48:49], v249 offset:16384
  ds_read_b64_tr_b16 v[50:51], v249 offset:17408
  ds_read_b128 v[36:39], v246 offset:25600
  ds_read_b64_tr_b16 v[52:53], v249 offset:18432
  ds_read_b64_tr_b16 v[54:55], v249 offset:19456
  v_readlane_b32 s95, v250, 21
  s_add_u32 m0, s87, 73728
  s_nop 3
  buffer_load_dwordx4 v245, s[16:19], s95 offen lds
  s_waitcnt vmcnt(6)
  v_cmp_ne_u32 vcc, s48, v113
  s_nop 0
  s_cmp_eq_u64 vcc, 0
  s_nop 1
  s_cbranch_scc1 L_apok_32
  s_lshr_b32 s51, s46, 1
  s_lshl_b32 s51, s51, 7
  s_add_u32 s51, s51, 13893632
  v_and_b32 v3, 14, v0
  v_lshlrev_b32 v3, 3, v3
  v_and_b32 v2, 1, v0
  v_lshl_add_u32 v3, v2, 2, v3
  s_mov_b32 s88, 0x40000
L_app_33:
  buffer_load_dword v113, v3, s[24:27], s51 offen sc1
  s_waitcnt vmcnt(0)
  v_cmp_ne_u32 vcc, s48, v113
  s_sub_u32 s88, s88, 1
  s_cmp_eq_u32 s88, 0
  s_nop 1
  s_cbranch_scc1 L_apok_32
  s_cmp_eq_u64 vcc, 0
  s_cbranch_scc0 L_app_33
L_apok_32:
  s_lshl_b32 s51, s46, 1
  s_and_b32 s52, s3, 1
  s_add_u32 s51, s51, s52
  s_lshl_b32 s51, s51, 7
  s_add_u32 s51, s51, 14155776
  v_and_b32 v2, 31, v0
  v_lshlrev_b32 v2, 2, v2
  buffer_load_dword v112, v2, s[24:27], s51 offen sc1
  v_readlane_b32 s97, v251, 15
  s_add_u32 m0, s87, 106496
  s_nop 3
  buffer_load_dwordx4 v244, s[24:27], s97 offen sc1 lds
  s_waitcnt lgkmcnt(3)
  v_mfma_f32_32x32x16_bf16 v[16:31], v[48:51], v[32:35], v[16:31]
  s_waitcnt lgkmcnt(0)
  v_mfma_f32_32x32x16_bf16 v[16:31], v[52:55], v[36:39], v[16:31]
  s_waitcnt vmcnt(5)
  s_barrier
  ds_read_b128 v[32:35], v246 offset:32768
  ds_read_b64_tr_b16 v[48:49], v249 offset:24576
  ds_read_b64_tr_b16 v[50:51], v249 offset:25600
  ds_read_b128 v[36:39], v246 offset:33792
  ds_read_b64_tr_b16 v[52:53], v249 offset:26624
  ds_read_b64_tr_b16 v[54:55], v249 offset:27648
  s_lshl_b32 s51, s44, 7
  s_lshl_b32 s52, s45, 2
  s_add_u32 s51, s51, s52
  s_add_u32 s51, s51, 13634560
  s_cmp_lg_u32 s3, 0
  s_cbranch_scc1 L_noflag_34
  v_mov_b32 v3, s48
  v_mov_b32 v2, 0
  s_mov_b64 exec, 1
  buffer_store_dword v3, v2, s[24:27], s51 offen sc1
  s_mov_b64 exec, -1
L_noflag_34:
  v_readlane_b32 s94, v250, 22
  s_add_u32 m0, s87, 81920
  s_nop 3
  buffer_load_dwordx4 v245, s[16:19], s94 offen lds
  v_readlane_b32 s96, v251, 16
  s_add_u32 m0, s87, 114688
  s_nop 3
  buffer_load_dwordx4 v244, s[24:27], s96 offen sc1 lds
  s_waitcnt lgkmcnt(3)
  v_mfma_f32_32x32x16_bf16 v[16:31], v[48:51], v[32:35], v[16:31]
  s_waitcnt lgkmcnt(0)
  v_mfma_f32_32x32x16_bf16 v[16:31], v[52:55], v[36:39], v[16:31]
  s_waitcnt vmcnt(12)
  s_barrier
  ds_read_b128 v[32:35], v246 offset:40960
  ds_read_b64_tr_b16 v[48:49], v247 offset:0
  ds_read_b64_tr_b16 v[50:51], v247 offset:1024
  ds_read_b128 v[36:39], v246 offset:41984
  ds_read_b64_tr_b16 v[52:53], v247 offset:2048
  ds_read_b64_tr_b16 v[54:55], v247 offset:3072
  v_readlane_b32 s95, v250, 23
  s_add_u32 m0, s87, 90112
  s_nop 3
  buffer_load_dwordx4 v245, s[16:19], s95 offen lds
  v_readlane_b32 s97, v251, 17
  s_add_u32 m0, s87, 122880
  s_nop 3
  buffer_load_dwordx4 v244, s[24:27], s97 offen sc1 lds
  s_waitcnt lgkmcnt(3)
  v_mfma_f32_32x32x16_bf16 v[16:31], v[48:51], v[32:35], v[16:31]
  s_waitcnt lgkmcnt(0)
  v_mfma_f32_32x32x16_bf16 v[16:31], v[52:55], v[36:39], v[16:31]
  s_waitcnt vmcnt(11)
  s_barrier
  ds_read_b128 v[32:35], v246 offset:49152
  ds_read_b64_tr_b16 v[48:49], v247 offset:8192
  ds_read_b64_tr_b16 v[50:51], v247 offset:9216
  ds_read_b128 v[36:39], v246 offset:50176
  ds_read_b64_tr_b16 v[52:53], v247 offset:10240
  ds_read_b64_tr_b16 v[54:55], v247 offset:11264
  v_readlane_b32 s94, v250, 24
  s_add_u32 m0, s87, 0
  s_nop 3
  buffer_load_dwordx4 v245, s[16:19], s94 offen lds
  v_readlane_b32 s96, v251, 18
  s_add_u32 m0, s87, 131072
  s_nop 3
  buffer_load_dwordx4 v244, s[24:27], s96 offen sc1 lds
  s_waitcnt lgkmcnt(3)
  v_mfma_f32_32x32x16_bf16 v[16:31], v[48:51], v[32:35], v[16:31]
  s_waitcnt lgkmcnt(0)
  v_mfma_f32_32x32x16_bf16 v[16:31], v[52:55], v[36:39], v[16:31]
  s_waitcnt vmcnt(9)
  s_barrier
  ds_read_b128 v[32:35], v246 offset:0
  ds_read_b64_tr_b16 v[48:49], v247 offset:16384
  ds_read_b64_tr_b16 v[50:51], v247 offset:17408
  ds_read_b128 v[36:39], v246 offset:1024
  ds_read_b64_tr_b16 v[52:53], v247 offset:18432
  ds_read_b64_tr_b16 v[54:55], v247 offset:19456
  v_readlane_b32 s95, v250, 25
  s_add_u32 m0, s87, 8192
  s_nop 3
  buffer_load_dwordx4 v245, s[16:19], s95 offen lds
  v_readlane_b32 s97, v251, 19
  s_add_u32 m0, s87, 139264
  s_nop 3
  buffer_load_dwordx4 v244, s[24:27], s97 offen sc1 lds
  s_waitcnt lgkmcnt(3)
  v_mfma_f32_32x32x16_bf16 v[16:31], v[48:51], v[32:35], v[16:31]
  s_waitcnt lgkmcnt(0)
  v_mfma_f32_32x32x16_bf16 v[16:31], v[52:55], v[36:39], v[16:31]
  s_waitcnt vmcnt(8)
  s_barrier
  ds_read_b128 v[32:35], v246 offset:8192
  ds_read_b64_tr_b16 v[48:49], v247 offset:24576
  ds_read_b64_tr_b16 v[50:51], v247 offset:25600
  ds_read_b128 v[36:39], v246 offset:9216
  ds_read_b64_tr_b16 v[52:53], v247 offset:26624
  ds_read_b64_tr_b16 v[54:55], v247 offset:27648
  v_readlane_b32 s94, v250, 26
  s_add_u32 m0, s87, 16384
  s_nop 3
  buffer_load_dwordx4 v245, s[16:19], s94 offen lds
  v_readlane_b32 s96, v251, 20
  s_add_u32 m0, s87, 147456
  s_nop 3
  buffer_load_dwordx4 v244, s[24:27], s96 offen sc1 lds
  s_waitcnt lgkmcnt(3)
  v_mfma_f32_32x32x16_bf16 v[16:31], v[48:51], v[32:35], v[16:31]
  s_waitcnt lgkmcnt(0)
  v_mfma_f32_32x32x16_bf16 v[16:31], v[52:55], v[36:39], v[16:31]
  s_waitcnt vmcnt(8)
  s_barrier
  ds_read_b128 v[32:35], v246 offset:16384
  ds_read_b64_tr_b16 v[48:49], v247 offset:32768
  ds_read_b64_tr_b16 v[50:51], v247 offset:33792
  ds_read_b128 v[36:39], v246 offset:17408
  ds_read_b64_tr_b16 v[52:53], v247 offset:34816
  ds_read_b64_tr_b16 v[54:55], v247 offset:35840
  v_readlane_b32 s95, v250, 27
  s_add_u32 m0, s87, 24576
  s_nop 3
  buffer_load_dwordx4 v245, s[16:19], s95 offen lds
  v_readlane_b32 s97, v251, 21
  s_add_u32 m0, s87, 98304
  s_nop 3
  buffer_load_dwordx4 v244, s[24:27], s97 offen sc1 lds
  s_waitcnt lgkmcnt(3)
  v_mfma_f32_32x32x16_bf16 v[16:31], v[48:51], v[32:35], v[16:31]
  s_waitcnt lgkmcnt(0)
  v_mfma_f32_32x32x16_bf16 v[16:31], v[52:55], v[36:39], v[16:31]
  s_waitcnt vmcnt(8)
  s_barrier
  ds_read_b128 v[32:35], v246 offset:24576
  ds_read_b64_tr_b16 v[48:49], v247 offset:40960
  ds_read_b64_tr_b16 v[50:51], v247 offset:41984
  ds_read_b128 v[36:39], v246 offset:25600
  ds_read_b64_tr_b16 v[52:53], v247 offset:43008
  ds_read_b64_tr_b16 v[54:55], v247 offset:44032
  s_add_u32 m0, s87, 32768
  s_add_u32 s50, s86, 0
  buffer_load_dwordx4 v245, s[20:23], s50 offen lds
  v_readlane_b32 s96, v251, 22
  s_add_u32 m0, s87, 106496
  s_nop 3
  buffer_load_dwordx4 v244, s[24:27], s96 offen sc1 lds
  s_waitcnt lgkmcnt(3)
  v_mfma_f32_32x32x16_bf16 v[16:31], v[48:51], v[32:35], v[16:31]
  s_waitcnt lgkmcnt(0)
  v_mfma_f32_32x32x16_bf16 v[16:31], v[52:55], v[36:39], v[16:31]
  s_waitcnt vmcnt(8)
  s_barrier
  ds_read_b128 v[32:35], v246 offset:32768
  ds_read_b64_tr_b16 v[48:49], v247 offset:49152
  ds_read_b64_tr_b16 v[50:51], v247 offset:50176
  ds_read_b128 v[36:39], v246 offset:33792
  ds_read_b64_tr_b16 v[52:53], v247 offset:51200
  ds_read_b64_tr_b16 v[54:55], v247 offset:52224
  s_add_u32 m0, s87, 40960
  s_add_u32 s50, s86, 50176
  buffer_load_dwordx4 v245, s[20:23], s50 offen lds
  v_readlane_b32 s97, v251, 23
  s_add_u32 m0, s87, 114688
  s_nop 3
  buffer_load_dwordx4 v244, s[24:27], s97 offen sc1 lds
  s_waitcnt lgkmcnt(3)
  v_mfma_f32_32x32x16_bf16 v[16:31], v[48:51], v[32:35], v[16:31]
  s_waitcnt lgkmcnt(0)
  v_mfma_f32_32x32x16_bf16 v[16:31], v[52:55], v[36:39], v[16:31]
  s_waitcnt vmcnt(8)
  s_barrier
  ds_read_b128 v[32:35], v246 offset:40960
  ds_read_b64_tr_b16 v[48:49], v247 offset:57344
  ds_read_b64_tr_b16 v[50:51], v247 offset:58368
  ds_read_b128 v[36:39], v246 offset:41984
  ds_read_b64_tr_b16 v[52:53], v247 offset:59392
  ds_read_b64_tr_b16 v[54:55], v247 offset:60416
  s_add_u32 m0, s87, 49152
  s_add_u32 s50, s86, 100352
  buffer_load_dwordx4 v245, s[20:23], s50 offen lds
  v_readlane_b32 s96, v251, 24
  s_add_u32 m0, s87, 122880
  s_nop 3
  buffer_load_dwordx4 v244, s[24:27], s96 offen sc1 lds
  s_waitcnt lgkmcnt(3)
  v_mfma_f32_32x32x16_bf16 v[16:31], v[48:51], v[32:35], v[16:31]
  s_waitcnt lgkmcnt(0)
  v_mfma_f32_32x32x16_bf16 v[16:31], v[52:55], v[36:39], v[16:31]
  s_waitcnt vmcnt(8)
  s_barrier
  ds_read_b128 v[32:35], v246 offset:49152
  ds_read_b64_tr_b16 v[48:49], v249 offset:0
  ds_read_b64_tr_b16 v[50:51], v249 offset:1024
  ds_read_b128 v[36:39], v246 offset:50176
  ds_read_b64_tr_b16 v[52:53], v249 offset:2048
  ds_read_b64_tr_b16 v[54:55], v249 offset:3072
  s_add_u32 m0, s87, 57344
  s_add_u32 s50, s86, 150528
  buffer_load_dwordx4 v245, s[20:23], s50 offen lds
  v_readlane_b32 s97, v251, 25
  s_add_u32 m0, s87, 131072
  s_nop 3
  buffer_load_dwordx4 v244, s[24:27], s97 offen sc1 lds
  s_waitcnt lgkmcnt(3)
  v_mfma_f32_32x32x16_bf16 v[16:31], v[48:51], v[32:35], v[16:31]
  s_waitcnt lgkmcnt(0)
  v_mfma_f32_32x32x16_bf16 v[16:31], v[52:55], v[36:39], v[16:31]
  s_waitcnt vmcnt(8)
  s_barrier
  ds_read_b128 v[32:35], v246 offset:0
  ds_read_b64_tr_b16 v[48:49], v249 offset:8192
  ds_read_b64_tr_b16 v[50:51], v249 offset:9216
  ds_read_b128 v[36:39], v246 offset:1024
  ds_read_b64_tr_b16 v[52:53], v249 offset:10240
  ds_read_b64_tr_b16 v[54:55], v249 offset:11264
  s_add_u32 m0, s87, 65536
  s_add_u32 s50, s86, 200704
  buffer_load_dwordx4 v245, s[20:23], s50 offen lds
  v_readlane_b32 s96, v251, 26
  s_add_u32 m0, s87, 139264
  s_nop 3
  buffer_load_dwordx4 v244, s[24:27], s96 offen sc1 lds
  s_waitcnt lgkmcnt(3)
  v_mfma_f32_32x32x16_bf16 v[16:31], v[48:51], v[32:35], v[16:31]
  s_waitcnt lgkmcnt(0)
  v_mfma_f32_32x32x16_bf16 v[16:31], v[52:55], v[36:39], v[16:31]
  s_waitcnt vmcnt(8)
  s_barrier
  ds_read_b128 v[32:35], v246 offset:8192
  ds_read_b64_tr_b16 v[48:49], v249 offset:16384
  ds_read_b64_tr_b16 v[50:51], v249 offset:17408
  ds_read_b128 v[36:39], v246 offset:9216
  ds_read_b64_tr_b16 v[52:53], v249 offset:18432
  ds_read_b64_tr_b16 v[54:55], v249 offset:19456
  s_add_u32 m0, s87, 73728
  s_add_u32 s50, s86, 250880
  buffer_load_dwordx4 v245, s[20:23], s50 offen lds
  s_lshr_b32 s51, s46, 1
  s_lshl_b32 s51, s51, 7
  s_add_u32 s51, s51, 13634560
  v_and_b32 v3, 7, v0
  v_lshlrev_b32 v3, 2, v3
  buffer_load_dword v113, v3, s[24:27], s51 offen sc1
  v_readlane_b32 s97, v251, 27
  s_add_u32 m0, s87, 147456
  s_nop 3
  buffer_load_dwordx4 v244, s[24:27], s97 offen sc1 lds
  s_waitcnt lgkmcnt(3)
  v_mfma_f32_32x32x16_bf16 v[16:31], v[48:51], v[32:35], v[16:31]
  s_waitcnt lgkmcnt(0)
  v_mfma_f32_32x32x16_bf16 v[16:31], v[52:55], v[36:39], v[16:31]
  s_waitcnt vmcnt(9)
  s_barrier
  ds_read_b128 v[32:35], v246 offset:16384
  ds_read_b64_tr_b16 v[48:49], v249 offset:24576
  ds_read_b64_tr_b16 v[50:51], v249 offset:25600
  ds_read_b128 v[36:39], v246 offset:17408
  ds_read_b64_tr_b16 v[52:53], v249 offset:26624
  ds_read_b64_tr_b16 v[54:55], v249 offset:27648
  s_add_u32 m0, s87, 81920
  s_add_u32 s50, s86, 301056
  buffer_load_dwordx4 v245, s[20:23], s50 offen lds
  s_waitcnt lgkmcnt(3)
  v_mfma_f32_32x32x16_bf16 v[16:31], v[48:51], v[32:35], v[16:31]
  s_waitcnt lgkmcnt(0)
  v_mfma_f32_32x32x16_bf16 v[16:31], v[52:55], v[36:39], v[16:31]
  s_waitcnt vmcnt(8)
  s_barrier
  ds_read_b128 v[32:35], v246 offset:24576
  ds_read_b64_tr_b16 v[48:49], v247 offset:0
  ds_read_b64_tr_b16 v[50:51], v247 offset:1024
  ds_read_b128 v[36:39], v246 offset:25600
  ds_read_b64_tr_b16 v[52:53], v247 offset:2048
  ds_read_b64_tr_b16 v[54:55], v247 offset:3072
  s_add_u32 m0, s87, 90112
  s_add_u32 s50, s86, 351232
  buffer_load_dwordx4 v245, s[20:23], s50 offen lds
  s_waitcnt vmcnt(3)
  v_cmp_ne_u32 vcc, s48, v113
  s_nop 0
  s_cmp_eq_u64 vcc, 0
  s_nop 1
  s_cbranch_scc1 L_apok_35
  s_lshr_b32 s51, s46, 1
  s_lshl_b32 s51, s51, 7
  s_add_u32 s51, s51, 13634560
  v_and_b32 v3, 7, v0
  v_lshlrev_b32 v3, 2, v3
  s_mov_b32 s88, 0x40000
L_app_36:
  buffer_load_dword v113, v3, s[24:27], s51 offen sc1
  s_waitcnt vmcnt(0)
  v_cmp_ne_u32 vcc, s48, v113
  s_sub_u32 s88, s88, 1
  s_cmp_eq_u32 s88, 0
  s_nop 1
  s_cbranch_scc1 L_apok_35
  s_cmp_eq_u64 vcc, 0
  s_cbranch_scc0 L_app_36
L_apok_35:
  s_add_u32 m0, s87, 98304
  s_add_u32 s50, s84, 114688
  buffer_load_dwordx4 v244, s[24:27], s50 offen sc1 lds
  s_add_u32 m0, s87, 106496
  s_add_u32 s50, s84, 118784
  buffer_load_dwordx4 v244, s[24:27], s50 offen sc1 lds
  s_waitcnt lgkmcnt(3)
  v_mfma_f32_32x32x16_bf16 v[16:31], v[48:51], v[32:35], v[16:31]
  s_waitcnt lgkmcnt(0)
  v_mfma_f32_32x32x16_bf16 v[16:31], v[52:55], v[36:39], v[16:31]
  s_waitcnt vmcnt(9)
  s_barrier
  ds_read_b128 v[32:35], v246 offset:32768
  ds_read_b64_tr_b16 v[48:49], v247 offset:8192
  ds_read_b64_tr_b16 v[50:51], v247 offset:9216
  ds_read_b128 v[36:39], v246 offset:33792
  ds_read_b64_tr_b16 v[52:53], v247 offset:10240
  ds_read_b64_tr_b16 v[54:55], v247 offset:11264
  s_add_u32 m0, s87, 114688
  s_add_u32 s50, s84, 122880
  buffer_load_dwordx4 v244, s[24:27], s50 offen sc1 lds
  s_waitcnt lgkmcnt(3)
  v_mfma_f32_32x32x16_bf16 v[16:31], v[48:51], v[32:35], v[16:31]
  s_waitcnt lgkmcnt(0)
  v_mfma_f32_32x32x16_bf16 v[16:31], v[52:55], v[36:39], v[16:31]
  s_waitcnt vmcnt(8)
  s_barrier
  ds_read_b128 v[32:35], v246 offset:40960
  ds_read_b64_tr_b16 v[48:49], v247 offset:16384
  ds_read_b64_tr_b16 v[50:51], v247 offset:17408
  ds_read_b128 v[36:39], v246 offset:41984
  ds_read_b64_tr_b16 v[52:53], v247 offset:18432
  ds_read_b64_tr_b16 v[54:55], v247 offset:19456
  s_add_u32 m0, s87, 122880
  s_add_u32 s50, s84, 126976
  buffer_load_dwordx4 v244, s[24:27], s50 offen sc1 lds
  s_waitcnt lgkmcnt(3)
  v_mfma_f32_32x32x16_bf16 v[16:31], v[48:51], v[32:35], v[16:31]
  s_waitcnt lgkmcnt(0)
  v_mfma_f32_32x32x16_bf16 v[16:31], v[52:55], v[36:39], v[16:31]
  s_waitcnt vmcnt(6)
  s_barrier
  ds_read_b128 v[32:35], v246 offset:49152
  ds_read_b64_tr_b16 v[48:49], v247 offset:24576
  ds_read_b64_tr_b16 v[50:51], v247 offset:25600
  ds_read_b128 v[36:39], v246 offset:50176
  ds_read_b64_tr_b16 v[52:53], v247 offset:26624
  ds_read_b64_tr_b16 v[54:55], v247 offset:27648
  s_add_u32 m0, s87, 131072
  s_add_u32 s50, s84, 131072
  buffer_load_dwordx4 v244, s[24:27], s50 offen sc1 lds
  s_waitcnt lgkmcnt(3)
  v_mfma_f32_32x32x16_bf16 v[16:31], v[48:51], v[32:35], v[16:31]
  s_waitcnt lgkmcnt(0)
  v_mfma_f32_32x32x16_bf16 v[16:31], v[52:55], v[36:39], v[16:31]
  s_waitcnt vmcnt(4)
  s_barrier
  ds_read_b128 v[32:35], v246 offset:0
  ds_read_b64_tr_b16 v[48:49], v247 offset:32768
  ds_read_b64_tr_b16 v[50:51], v247 offset:33792
  ds_read_b128 v[36:39], v246 offset:1024
  ds_read_b64_tr_b16 v[52:53], v247 offset:34816
  ds_read_b64_tr_b16 v[54:55], v247 offset:35840
  s_add_u32 m0, s87, 139264
  s_add_u32 s50, s84, 135168
  buffer_load_dwordx4 v244, s[24:27], s50 offen sc1 lds
  s_waitcnt lgkmcnt(3)
  v_mfma_f32_32x32x16_bf16 v[96:111], v[48:51], v[32:35], 0
  s_waitcnt lgkmcnt(0)
  v_mfma_f32_32x32x16_bf16 v[96:111], v[52:55], v[36:39], v[96:111]
  s_waitcnt vmcnt(4)
  s_barrier
  ds_read_b128 v[32:35], v246 offset:8192
  ds_read_b64_tr_b16 v[48:49], v247 offset:40960
  ds_read_b64_tr_b16 v[50:51], v247 offset:41984
  ds_read_b128 v[36:39], v246 offset:9216
  ds_read_b64_tr_b16 v[52:53], v247 offset:43008
  ds_read_b64_tr_b16 v[54:55], v247 offset:44032
  s_add_u32 m0, s87, 147456
  s_add_u32 s50, s84, 139264
  buffer_load_dwordx4 v244, s[24:27], s50 offen sc1 lds
  s_waitcnt lgkmcnt(3)
  v_mfma_f32_32x32x16_bf16 v[96:111], v[48:51], v[32:35], v[96:111]
  s_waitcnt lgkmcnt(0)
  v_mfma_f32_32x32x16_bf16 v[96:111], v[52:55], v[36:39], v[96:111]
  s_waitcnt vmcnt(4)
  s_barrier
  ds_read_b128 v[32:35], v246 offset:16384
  ds_read_b64_tr_b16 v[48:49], v247 offset:49152
  ds_read_b64_tr_b16 v[50:51], v247 offset:50176
  ds_read_b128 v[36:39], v246 offset:17408
  ds_read_b64_tr_b16 v[52:53], v247 offset:51200
  ds_read_b64_tr_b16 v[54:55], v247 offset:52224
  s_add_u32 m0, s87, 98304
  s_add_u32 s50, s84, 143360
  buffer_load_dwordx4 v244, s[24:27], s50 offen sc1 lds
  s_waitcnt lgkmcnt(3)
  v_mfma_f32_32x32x16_bf16 v[96:111], v[48:51], v[32:35], v[96:111]
  s_waitcnt lgkmcnt(0)
  v_mfma_f32_32x32x16_bf16 v[96:111], v[52:55], v[36:39], v[96:111]
  s_waitcnt vmcnt(4)
  s_barrier
  ds_read_b128 v[32:35], v246 offset:24576
  ds_read_b64_tr_b16 v[48:49], v247 offset:57344
  ds_read_b64_tr_b16 v[50:51], v247 offset:58368
  ds_read_b128 v[36:39], v246 offset:25600
  ds_read_b64_tr_b16 v[52:53], v247 offset:59392
  ds_read_b64_tr_b16 v[54:55], v247 offset:60416
  s_waitcnt lgkmcnt(3)
  v_mfma_f32_32x32x16_bf16 v[96:111], v[48:51], v[32:35], v[96:111]
  s_waitcnt lgkmcnt(0)
  v_mfma_f32_32x32x16_bf16 v[96:111], v[52:55], v[36:39], v[96:111]
  s_waitcnt vmcnt(3)
  s_barrier
  ds_read_b128 v[32:35], v246 offset:32768
  ds_read_b64_tr_b16 v[48:49], v249 offset:0
  ds_read_b64_tr_b16 v[50:51], v249 offset:1024
  ds_read_b128 v[36:39], v246 offset:33792
  ds_read_b64_tr_b16 v[52:53], v249 offset:2048
  ds_read_b64_tr_b16 v[54:55], v249 offset:3072
  s_waitcnt lgkmcnt(3)
  v_mfma_f32_32x32x16_bf16 v[96:111], v[48:51], v[32:35], v[96:111]
  s_waitcnt lgkmcnt(0)
  v_mfma_f32_32x32x16_bf16 v[96:111], v[52:55], v[36:39], v[96:111]
  s_waitcnt vmcnt(2)
  s_barrier
  ds_read_b128 v[32:35], v246 offset:40960
  ds_read_b64_tr_b16 v[48:49], v249 offset:8192
  ds_read_b64_tr_b16 v[50:51], v249 offset:9216
  ds_read_b128 v[36:39], v246 offset:41984
  ds_read_b64_tr_b16 v[52:53], v249 offset:10240
  ds_read_b64_tr_b16 v[54:55], v249 offset:11264
  s_waitcnt lgkmcnt(3)
  v_mfma_f32_32x32x16_bf16 v[96:111], v[48:51], v[32:35], v[96:111]
  s_waitcnt lgkmcnt(0)
  v_mfma_f32_32x32x16_bf16 v[96:111], v[52:55], v[36:39], v[96:111]
  s_waitcnt vmcnt(1)
  s_barrier
  ds_read_b128 v[32:35], v246 offset:49152
  ds_read_b64_tr_b16 v[48:49], v249 offset:16384
  ds_read_b64_tr_b16 v[50:51], v249 offset:17408
  ds_read_b128 v[36:39], v246 offset:50176
  ds_read_b64_tr_b16 v[52:53], v249 offset:18432
  ds_read_b64_tr_b16 v[54:55], v249 offset:19456
  s_waitcnt lgkmcnt(3)
  v_mfma_f32_32x32x16_bf16 v[96:111], v[48:51], v[32:35], v[96:111]
  s_waitcnt lgkmcnt(0)
  v_mfma_f32_32x32x16_bf16 v[96:111], v[52:55], v[36:39], v[96:111]
  s_waitcnt vmcnt(0)
  s_barrier
  ds_read_b128 v[32:35], v246 offset:0
  ds_read_b64_tr_b16 v[48:49], v249 offset:24576
  ds_read_b64_tr_b16 v[50:51], v249 offset:25600
  ds_read_b128 v[36:39], v246 offset:1024
  ds_read_b64_tr_b16 v[52:53], v249 offset:26624
  ds_read_b64_tr_b16 v[54:55], v249 offset:27648
  s_waitcnt lgkmcnt(3)
  v_mfma_f32_32x32x16_bf16 v[96:111], v[48:51], v[32:35], v[96:111]
  s_waitcnt lgkmcnt(0)
  v_mfma_f32_32x32x16_bf16 v[96:111], v[52:55], v[36:39], v[96:111]
  s_waitcnt vmcnt(36)
  s_nop 10
  v_sub_f32 v96, v96, v16
  v_sub_f32 v97, v97, v17
  v_sub_f32 v98, v98, v18
  v_sub_f32 v99, v99, v19
  v_sub_f32 v100, v100, v20
  v_sub_f32 v101, v101, v21
  v_sub_f32 v102, v102, v22
  v_sub_f32 v103, v103, v23
  v_sub_f32 v104, v104, v24
  v_sub_f32 v105, v105, v25
  v_sub_f32 v106, v106, v26
  v_sub_f32 v107, v107, v27
  v_sub_f32 v108, v108, v28
  v_sub_f32 v109, v109, v29
  v_sub_f32 v110, v110, v30
  v_sub_f32 v111, v111, v31
  v_fmac_f32 v16, v112, v96
  v_fmac_f32 v17, v112, v97
  v_fmac_f32 v18, v112, v98
  v_fmac_f32 v19, v112, v99
  v_fmac_f32 v20, v112, v100
  v_fmac_f32 v21, v112, v101
  v_fmac_f32 v22, v112, v102
  v_fmac_f32 v23, v112, v103
  v_fmac_f32 v24, v112, v104
  v_fmac_f32 v25, v112, v105
  v_fmac_f32 v26, v112, v106
  v_fmac_f32 v27, v112, v107
  v_fmac_f32 v28, v112, v108
  v_fmac_f32 v29, v112, v109
  v_fmac_f32 v30, v112, v110
  v_fmac_f32 v31, v112, v111
  s_lshl_b32 s50, s3, 11
  s_add_u32 s50, s50, 0
  v_lshlrev_b32 v1, 4, v0
  v_add_u32 v2, s50, v1
  s_xor_b32 s51, s3, 4
  s_lshl_b32 s51, s51, 11
  s_add_u32 s51, s51, 0
  v_add_u32 v3, s51, v1
  v_and_b32 v4, 31, v0
  s_lshl_b32 s50, s46, 6
  s_and_b32 s51, s3, 1
  s_lshl_b32 s51, s51, 5
  s_add_u32 s50, s50, s51
  v_add_u32 v4, s50, v4
  v_mul_u32_u24 v4, 896, v4
  v_lshrrev_b32 v5, 5, v0
  v_lshl_add_u32 v4, v5, 4, v4
  s_lshl_b32 s50, s47, 7
  s_lshr_b32 s51, s3, 1
  s_and_b32 s51, s51, 1
  s_lshl_b32 s51, s51, 6
  s_add_u32 s50, s50, s51
  s_lshr_b32 s51, s3, 2
  s_lshl_b32 s51, s51, 5
  s_add_u32 s50, s50, s51
  s_cmp_ge_u32 s3, 4
  s_cbranch_scc1 L_kh1_37
  ds_write_b128 v2, v[24:27]
  ds_write_b128 v2, v[28:31] offset:1024
  s_branch L_khj_38
L_kh1_37:
  ds_write_b128 v2, v[16:19]
  ds_write_b128 v2, v[20:23] offset:1024
  v_mov_b32 v16, v24
  v_mov_b32 v17, v25
  v_mov_b32 v18, v26
  v_mov_b32 v19, v27
  v_mov_b32 v20, v28
  v_mov_b32 v21, v29
  v_mov_b32 v22, v30
  v_mov_b32 v23, v31
L_khj_38:
  s_waitcnt lgkmcnt(0)
  s_barrier
  ds_read_b128 v[32:35], v3
  ds_read_b128 v[36:39], v3 offset:1024
  s_waitcnt lgkmcnt(0)
  v_add_f32 v16, v16, v32
  v_add_f32 v17, v17, v33
  v_add_f32 v18, v18, v34
  v_add_f32 v19, v19, v35
  v_add_f32 v20, v20, v36
  v_add_f32 v21, v21, v37
  v_add_f32 v22, v22, v38
  v_add_f32 v23, v23, v39
  v_cvt_pk_bf16_f32 v40, v16, v17
  v_cvt_pk_bf16_f32 v41, v18, v19
  v_cvt_pk_bf16_f32 v42, v20, v21
  v_cvt_pk_bf16_f32 v43, v22, v23
  s_nop 0
  v_permlane32_swap_b32 v40, v42
  v_permlane32_swap_b32 v41, v43
  buffer_store_dwordx4 v[40:43], v4, s[28:31], s50 offen
  s_branch L_fin
L_fin:
L_end:
  s_endpgm
.section .rodata,"a"
.p2align 6
.amdhsa_kernel gated_mix__linear_kernel_hedgehog__dense_activation_silu__prompt_kernel
  .amdhsa_next_free_vgpr 256
  .amdhsa_next_free_sgpr 102
  .amdhsa_accum_offset 256
  .amdhsa_group_segment_fixed_size 0
  .amdhsa_kernarg_size 88
  .amdhsa_user_sgpr_count 2
  .amdhsa_user_sgpr_kernarg_segment_ptr 1
  .amdhsa_system_sgpr_workgroup_id_x 1
.end_amdhsa_kernel
```
